```python
import torch

def _softmax(x, axis=-1):
    return torch.softmax(x, dim=axis)
def _gelu(x):
    return torch.nn.functional.gelu(x, approximate="tanh")
def _silu(x):
    return torch.nn.functional.silu(x)
def _sigmoid(x):
    return torch.sigmoid(x)
def _layernorm(x, axis=-1, eps=1e-5):
    m = x.mean(dim=axis, keepdim=True)
    v = x.var(dim=axis, keepdim=True, unbiased=False)
    return (x - m) / torch.sqrt(v + eps)
def _scatter_add(tgt, idx, src, axis=0):
    return tgt.clone().index_add_(axis, idx, src)
def _segment_sum(src, seg, n):
    out = torch.zeros((n,) + src.shape[1:], dtype=src.dtype)
    return out.index_add_(0, seg, src)
def _pad(x, pw):
    flat = tuple(v for pair in reversed(pw) for v in pair)
    return torch.nn.functional.pad(x, flat)

kernel_name = 'standalone__mha_block_cached__near_ridge'

def setup_inputs():

    _w = (lambda a: (lambda t: t.to(torch.bfloat16) if t.is_floating_point() else t)(torch.as_tensor(a)))
    B, Sq, D = 8, 128, 1024
    H, Sk, Dh = 32, 2048, 128
    return {
        "x": _w((lambda *s: torch.randn(*s, dtype=torch.bfloat16) * 0.8)(B, Sq, D)),
        "k_cache": _w((lambda *s: torch.randn(*s, dtype=torch.bfloat16) * 0.8)(B, H, Sk, Dh)),
        "v_cache": _w((lambda *s: torch.randn(*s, dtype=torch.bfloat16) * 0.05)(B, H, Sk, Dh)),
        "wq": _w((lambda *s: torch.randn(*s, dtype=torch.bfloat16) * 0.8)(D, H * Dh) * (D ** -0.5)),
        "wo": _w((lambda *s: torch.randn(*s, dtype=torch.bfloat16) * 0.05)(H * Dh, D) * ((H * Dh) ** -0.5)),
    }

def reference(x, k_cache, v_cache, wq, wo):
    B, Sq, D = x.shape
    H, Dh = 32, 128
    q = (lambda x, *d: x.permute(*d))((x @ wq).reshape(B, Sq, H, Dh), 0, 2, 1, 3)
    scores = torch.einsum("bhqd,bhkd->bhqk", q, k_cache) * (Dh ** -0.5)
    p = _softmax(scores, axis=-1)
    o = torch.einsum("bhqk,bhkd->bhqd", p, v_cache)
    return (lambda x, *d: x.permute(*d))(o, 0, 2, 1, 3).reshape(B, Sq, H * Dh) @ wo
```

```asm
; @launch grid=(256,1,1) block=(256,1,1) lds=163840
.amdgcn_target "amdgcn-amd-amdhsa--gfx950"
.text
.globl standalone__mha_block_cached__near_ridge_kernel
.p2align 8
.type standalone__mha_block_cached__near_ridge_kernel,@function
standalone__mha_block_cached__near_ridge_kernel:
  s_cmp_ge_u32 s2, 256
  s_cbranch_scc1 L_end
  s_load_dwordx8 s[36:43], s[0:1], 0
  s_load_dwordx8 s[88:95], s[0:1], 32
  v_lshrrev_b32 v2, 6, v0
  v_and_b32 v1, 63, v0
  v_readfirstlane_b32 s29, v2
  s_and_b32 s55, s2, 3
  s_lshl_b32 s3, s55, 3
  s_lshr_b32 s4, s2, 3
  s_and_b32 s54, s4, 7
  s_add_u32 s34, s3, s54
  s_and_b32 s3, s2, 4
  s_lshr_b32 s4, s4, 3
  s_add_u32 s35, s3, s4
  s_lshl_b32 s30, s29, 12
  v_lshrrev_b32 v2, 4, v1
  v_and_b32 v3, 15, v1
  v_lshrrev_b32 v4, 3, v1
  v_and_b32 v5, 7, v1
  v_lshlrev_b32 v6, 1, v2
  v_xor_b32 v6, v6, v3
  v_lshlrev_b32 v6, 4, v6
  v_xor_b32 v9, 0x80, v6
  s_lshl_b32 s3, s29, 17
  v_lshl_add_u32 v7, v2, 13, v6
  v_add_u32 v44, s3, v7
  v_add_u32 v45, 31744, v44
  v_lshl_add_u32 v7, v2, 13, v9
  v_add_u32 v7, s3, v7
  v_add_u32 v46, 63488, v7
  v_add_u32 v47, 95232, v7
  s_lshl_b32 s3, s29, 16
  v_xor_b32 v7, v2, v5
  v_xor_b32 v8, 4, v7
  v_lshlrev_b32 v7, 4, v7
  v_lshlrev_b32 v8, 4, v8
  v_lshl_add_u32 v7, v4, 11, v7
  v_lshl_add_u32 v8, v4, 11, v8
  v_add_u32 v40, s3, v7
  v_add_u32 v8, s3, v8
  v_add_u32 v41, 15360, v8
  v_add_u32 v42, 30720, v40
  v_add_u32 v43, 46080, v8
  s_lshl_b32 s3, s34, 1
  s_mul_i32 s4, s35, 5
  s_add_u32 s3, s3, s4
  s_and_b32 s3, s3, 15
  s_lshl_b32 s31, s3, 7
  s_lshl_b32 s5, s35, 18
  s_lshl_b32 s6, s34, 8
  s_sub_u32 s14, 0x800000, s6
  s_waitcnt lgkmcnt(0)
  s_add_u32 s8, s36, s5
  s_addc_u32 s9, s37, 0
  s_mov_b32 s10, 0x40000
  s_mov_b32 s11, 0x00020000
  s_add_u32 s12, s42, s6
  s_addc_u32 s13, s43, 0
  s_mov_b32 s15, 0x00020000
  s_mov_b32 s28, 0
  s_lshl_b32 s7, s54, 2
  s_lshr_b32 s7, 0x31103110, s7
  s_and_b32 s7, s7, 15
  s_cbranch_scc0 L_grpa
  s_lshl_b32 s3, s35, 5
  s_add_u32 s3, s3, s34
  s_lshl_b32 s3, s3, 19
  s_add_u32 s16, s38, s3
  s_addc_u32 s17, s39, 0
  s_mov_b32 s18, 0x80000
  s_mov_b32 s19, 0x00020000
  s_add_u32 s20, s40, s3
  s_addc_u32 s21, s41, 0
  s_mov_b32 s22, 0x80000
  s_mov_b32 s23, 0x00020000
  v_lshl_add_u32 v7, v2, 8, v6
  v_add_u32 v12, s30, v7
  v_lshl_add_u32 v7, v2, 8, v9
  v_add_u32 v13, s30, v7
  s_lshl_b32 s3, s29, 3
  s_and_b32 s3, s3, 8
  v_xor_b32 v8, v2, v3
  v_xor_b32 v8, s3, v8
  v_xor_b32 v7, 0, v8
  v_lshlrev_b32 v7, 4, v7
  v_lshl_add_u32 v7, v2, 8, v7
  v_add_u32 v10, s30, v7
  v_xor_b32 v7, 4, v8
  v_lshlrev_b32 v7, 4, v7
  v_lshl_add_u32 v7, v2, 8, v7
  v_add_u32 v11, s30, v7
  s_mov_b32 s3, 327680
  s_mov_b32 s4, 360448
  buffer_load_dwordx4 a[128:131], v12, s[20:23], s3 offen offset:0 nt
  buffer_load_dwordx4 a[132:135], v12, s[20:23], s3 offen offset:1024 nt
  buffer_load_dwordx4 a[136:139], v13, s[20:23], s3 offen offset:2048 nt
  buffer_load_dwordx4 a[140:143], v13, s[20:23], s3 offen offset:3072 nt
  buffer_load_dwordx4 a[144:147], v10, s[16:19], s4 offen offset:0 nt
  buffer_load_dwordx4 a[148:151], v10, s[16:19], s4 offen offset:1024 nt
  buffer_load_dwordx4 a[152:155], v11, s[16:19], s4 offen offset:2048 nt
  buffer_load_dwordx4 a[156:159], v11, s[16:19], s4 offen offset:3072 nt
  s_or_b32 s28, s28, 16
  s_cmp_le_u32 s7, 1
  s_cbranch_scc1 L_grpa
  s_mov_b32 s3, 196608
  s_mov_b32 s4, 229376
  buffer_load_dwordx4 a[64:67], v12, s[20:23], s3 offen offset:0 nt
  buffer_load_dwordx4 a[68:71], v12, s[20:23], s3 offen offset:1024 nt
  buffer_load_dwordx4 a[72:75], v13, s[20:23], s3 offen offset:2048 nt
  buffer_load_dwordx4 a[76:79], v13, s[20:23], s3 offen offset:3072 nt
  buffer_load_dwordx4 a[80:83], v10, s[16:19], s4 offen offset:0 nt
  buffer_load_dwordx4 a[84:87], v10, s[16:19], s4 offen offset:1024 nt
  buffer_load_dwordx4 a[88:91], v11, s[16:19], s4 offen offset:2048 nt
  buffer_load_dwordx4 a[92:95], v11, s[16:19], s4 offen offset:3072 nt
  s_or_b32 s28, s28, 4
  s_cmp_le_u32 s7, 2
  s_cbranch_scc1 L_grpa
  s_mov_b32 s3, 393216
  s_mov_b32 s4, 425984
  buffer_load_dwordx4 a[160:163], v12, s[20:23], s3 offen offset:0 nt
  buffer_load_dwordx4 a[164:167], v12, s[20:23], s3 offen offset:1024 nt
  buffer_load_dwordx4 a[168:171], v13, s[20:23], s3 offen offset:2048 nt
  buffer_load_dwordx4 a[172:175], v13, s[20:23], s3 offen offset:3072 nt
  buffer_load_dwordx4 a[176:179], v10, s[16:19], s4 offen offset:0 nt
  buffer_load_dwordx4 a[180:183], v10, s[16:19], s4 offen offset:1024 nt
  buffer_load_dwordx4 a[184:187], v11, s[16:19], s4 offen offset:2048 nt
  buffer_load_dwordx4 a[188:191], v11, s[16:19], s4 offen offset:3072 nt
  s_or_b32 s28, s28, 32
L_grpa:
  s_add_u32 m0, s30, 16384
  s_lshl_b32 s32, s31, 12
  buffer_load_dwordx4 v40, s[8:11], s31 offen offset:0  lds
  buffer_load_dwordx4 v41, s[8:11], s31 offen offset:1024  lds
  buffer_load_dwordx4 v42, s[8:11], s31 offen offset:2048  lds
  buffer_load_dwordx4 v43, s[8:11], s31 offen offset:3072  lds
  s_add_u32 m0, s30, 98304
  s_add_u32 s31, s31, 128
  buffer_load_dwordx4 v44, s[12:15], s32 offen offset:0  lds
  s_and_b32 s31, s31, 0x7ff
  buffer_load_dwordx4 v45, s[12:15], s32 offen offset:1024  lds
  buffer_load_dwordx4 v46, s[12:15], s32 offen offset:2048  lds
  buffer_load_dwordx4 v47, s[12:15], s32 offen offset:3072  lds
  v_lshlrev_b32 v7, 4, v1
  v_add_u32 v7, s30, v7
  v_add_u32 v31, 98304, v7
  s_mov_b32 s24, s94
  s_mov_b32 s25, s95
  s_mov_b32 s26, 0x2000000
  s_mov_b32 s27, 0x00020000
  s_mov_b32 s56, s88
  s_mov_b32 s57, s89
  s_mov_b32 s58, 0x800000
  s_mov_b32 s59, 0x00020000
  s_mov_b32 s60, s90
  s_mov_b32 s61, s91
  s_mov_b32 s62, 0x200000
  s_mov_b32 s63, 0x00020000
  s_mov_b32 s64, s92
  s_mov_b32 s65, s93
  s_mov_b32 s66, 256
  s_mov_b32 s67, 0x00020000
  s_mov_b64 s[78:79], exec
  s_lshl_b32 s3, s35, 2
  s_add_u32 s3, s3, s55
  s_lshl_b32 s3, s3, 11
  s_lshl_b32 s4, s29, 8
  s_add_u32 s74, s3, 0x1800000
  s_lshl_b32 s3, s35, 3
  s_add_u32 s5, s3, s54
  s_lshl_b32 s3, s5, 10
  s_add_u32 s3, s3, s4
  s_add_u32 s75, s3, 0x1810000
  s_lshl_b32 s3, s54, 6
  s_add_u32 s3, s3, s29
  s_lshl_b32 s3, s3, 2
  s_lshl_b32 s4, s55, 2
  v_mov_b32 v36, s3
  v_mov_b32 v37, s4
  v_mov_b32 v38, 0
  v_mov_b32 v39, 0
  s_lshl_b32 s3, s5, 18
  s_add_u32 s3, s3, s30
  s_add_u32 s81, s3, 0x800000
  s_mul_i32 s3, s55, 0x14000
  s_add_u32 s3, s3, s81
  s_lshl_b32 s4, s35, 18
  s_mov_b64 exec, 1
  buffer_atomic_swap v38, v36, s[24:27], s74 offen sc0 sc1
  buffer_atomic_swap v39, v37, s[24:27], s75 offen sc0 sc1
  s_mov_b64 exec, s[78:79]
  s_lshl_b32 s3, s35, 5
  s_add_u32 s3, s3, s34
  s_lshl_b32 s3, s3, 19
  s_add_u32 s16, s38, s3
  s_addc_u32 s17, s39, 0
  s_mov_b32 s18, 0x80000
  s_mov_b32 s19, 0x00020000
  s_add_u32 s20, s40, s3
  s_addc_u32 s21, s41, 0
  s_mov_b32 s22, 0x80000
  s_mov_b32 s23, 0x00020000
  v_lshl_add_u32 v7, v2, 8, v6
  v_add_u32 v12, s30, v7
  v_lshl_add_u32 v7, v2, 8, v9
  v_add_u32 v13, s30, v7
  s_lshl_b32 s3, s29, 3
  s_and_b32 s3, s3, 8
  v_xor_b32 v8, v2, v3
  v_xor_b32 v8, s3, v8
  v_xor_b32 v7, 0, v8
  v_lshlrev_b32 v7, 4, v7
  v_lshl_add_u32 v7, v2, 8, v7
  v_add_u32 v10, s30, v7
  v_xor_b32 v7, 4, v8
  v_lshlrev_b32 v7, 4, v7
  v_lshl_add_u32 v7, v2, 8, v7
  v_add_u32 v11, s30, v7
  s_mov_b32 s49, 0
  s_mov_b32 s50, 0
  s_mov_b32 s3, 0x76325410
  s_bitcmp1_b32 s54, 1
  s_cselect_b32 s97, 0x54176320, s3
  s_mul_i32 s3, s54, 0x11111111
  s_xor_b32 s97, s97, s3
  s_mov_b32 s72, s97
  s_lshl_b32 s3, s55, 21
  s_lshl_b32 s4, s29, 16
  s_add_u32 s73, s3, s4
  s_lshr_b32 s3, s54, 1
  s_and_b32 s4, s54, 1
  s_lshl_b32 s4, s4, 2
  s_add_u32 s3, s3, s4
  s_lshl_b32 s44, s3, 7
  s_add_u32 s3, s3, 2
  s_and_b32 s3, s3, 7
  s_add_u32 s3, s3, 7
  s_lshl_b32 s45, s3, 7
  v_lshlrev_b32 v6, 2, v2
  v_xor_b32 v6, v6, v3
  v_lshlrev_b32 v6, 4, v6
  v_lshl_add_u32 v14, v2, 11, v6
  v_mov_b32 v7, s44
  v_mov_b32 v8, s45
  v_cmp_gt_u32 vcc, 128, v6
  s_nop 1
  v_cndmask_b32 v7, v8, v7, vcc
  v_add_u32 v14, v7, v14
  v_and_b32 v4, 12, v3
  v_and_b32 v5, 3, v3
  v_lshl_add_u32 v4, v4, 1, v5
  v_and_b32 v5, 1, v2
  v_lshlrev_b32 v5, 1, v5
  v_lshrrev_b32 v6, 1, v2
  v_or_b32 v5, v5, v6
  v_xor_b32 v5, v5, v3
  v_xor_b32 v6, 0, v5
  v_lshlrev_b32 v6, 4, v6
  v_lshl_add_u32 v16, v4, 8, v6
  v_xor_b32 v6, 4, v5
  v_lshlrev_b32 v6, 4, v6
  v_lshl_add_u32 v17, v4, 8, v6
  v_xor_b32 v6, 8, v5
  v_lshlrev_b32 v6, 4, v6
  v_lshl_add_u32 v18, v4, 8, v6
  v_xor_b32 v6, 12, v5
  v_lshlrev_b32 v6, 4, v6
  v_lshl_add_u32 v19, v4, 8, v6
  v_lshrrev_b32 v5, 1, v3
  v_xor_b32 v5, v5, v2
  v_xor_b32 v6, 0, v5
  v_lshlrev_b32 v6, 4, v6
  v_lshl_add_u32 v6, v3, 7, v6
  v_add_u32 v6, s30, v6
  v_add_u32 v62, 0x4000, v6
  v_xor_b32 v6, 4, v5
  v_lshlrev_b32 v6, 4, v6
  v_lshl_add_u32 v6, v3, 7, v6
  v_add_u32 v6, s30, v6
  v_add_u32 v63, 0x4000, v6
  v_lshrrev_b32 v4, 2, v3
  v_lshl_add_u32 v5, v2, 3, v4
  v_lshlrev_b32 v5, 8, v5
  v_and_b32 v6, 1, v1
  v_lshl_add_u32 v5, v6, 3, v5
  v_add_u32 v5, 98304, v5
  v_and_b32 v6, 1, v2
  v_lshl_add_u32 v6, v6, 2, v4
  v_lshlrev_b32 v6, 1, v6
  v_lshrrev_b32 v7, 1, v1
  v_and_b32 v7, 1, v7
  v_or_b32 v6, v6, v7
  v_xor_b32 v7, 0, v6
  v_lshl_add_u32 v20, v7, 4, v5
  v_add_u32 v64, -16384, v20
  v_xor_b32 v7, 2, v6
  v_lshl_add_u32 v21, v7, 4, v5
  v_add_u32 v65, -16384, v21
  v_xor_b32 v7, 4, v6
  v_lshl_add_u32 v22, v7, 4, v5
  v_add_u32 v66, -16384, v22
  v_xor_b32 v7, 6, v6
  v_lshl_add_u32 v23, v7, 4, v5
  v_add_u32 v67, -16384, v23
  v_xor_b32 v7, 8, v6
  v_lshl_add_u32 v24, v7, 4, v5
  v_add_u32 v68, -16384, v24
  v_xor_b32 v7, 10, v6
  v_lshl_add_u32 v25, v7, 4, v5
  v_add_u32 v69, -16384, v25
  v_xor_b32 v7, 12, v6
  v_lshl_add_u32 v26, v7, 4, v5
  v_add_u32 v70, -16384, v26
  v_xor_b32 v7, 14, v6
  v_lshl_add_u32 v27, v7, 4, v5
  v_add_u32 v71, -16384, v27
  v_lshl_add_u32 v5, v2, 2, v4
  v_lshlrev_b32 v5, 8, v5
  v_add_u32 v5, 0x10000, v5
  s_lshl_b32 s3, s29, 2
  v_xor_b32 v6, s3, v3
  v_lshl_add_u32 v28, v6, 4, v5
  v_lshlrev_b32 v15, 4, v1
  v_mov_b32 v88, 0
  v_mov_b32 v89, 0
  v_mov_b32 v90, 0
  v_mov_b32 v91, 0
  v_mov_b32 v92, 0
  v_mov_b32 v93, 0
  v_mov_b32 v94, 0
  v_mov_b32 v95, 0
  v_mov_b32 v96, 0
  v_mov_b32 v97, 0
  v_mov_b32 v98, 0
  v_mov_b32 v99, 0
  v_mov_b32 v100, 0
  v_mov_b32 v101, 0
  v_mov_b32 v102, 0
  v_mov_b32 v103, 0
  v_mov_b32 v104, 0
  v_mov_b32 v105, 0
  v_mov_b32 v106, 0
  v_mov_b32 v107, 0
  v_mov_b32 v108, 0
  v_mov_b32 v109, 0
  v_mov_b32 v110, 0
  v_mov_b32 v111, 0
  v_mov_b32 v112, 0
  v_mov_b32 v113, 0
  v_mov_b32 v114, 0
  v_mov_b32 v115, 0
  v_mov_b32 v116, 0
  v_mov_b32 v117, 0
  v_mov_b32 v118, 0
  v_mov_b32 v119, 0
  v_mov_b32 v120, 0
  v_mov_b32 v121, 0
  v_mov_b32 v122, 0
  v_mov_b32 v123, 0
  v_mov_b32 v124, 0
  v_mov_b32 v125, 0
  v_mov_b32 v126, 0
  v_mov_b32 v127, 0
  v_mov_b32 v128, 0
  v_mov_b32 v129, 0
  v_mov_b32 v130, 0
  v_mov_b32 v131, 0
  v_mov_b32 v132, 0
  v_mov_b32 v133, 0
  v_mov_b32 v134, 0
  v_mov_b32 v135, 0
  v_mov_b32 v136, 0
  v_mov_b32 v137, 0
  v_mov_b32 v138, 0
  v_mov_b32 v139, 0
  v_mov_b32 v140, 0
  v_mov_b32 v141, 0
  v_mov_b32 v142, 0
  v_mov_b32 v143, 0
  v_mov_b32 v144, 0
  v_mov_b32 v145, 0
  v_mov_b32 v146, 0
  v_mov_b32 v147, 0
  v_mov_b32 v148, 0
  v_mov_b32 v149, 0
  v_mov_b32 v150, 0
  v_mov_b32 v151, 0
  s_mov_b32 s52, 0x3e0293ee
  s_mov_b32 s53, 0x3e0293ee
  s_mov_b32 s51, 0x41000000
  v_mov_b32 v248, 0x3f803f80
  v_mov_b32 v249, 0x3f803f80
  v_mov_b32 v250, 0x3f803f80
  v_mov_b32 v251, 0x3f803f80
  s_mov_b32 s33, 0
  s_add_u32 m0, s30, 32768
  s_lshl_b32 s32, s31, 12
  buffer_load_dwordx4 v40, s[8:11], s31 offen offset:0  lds
  buffer_load_dwordx4 v41, s[8:11], s31 offen offset:1024  lds
  buffer_load_dwordx4 v42, s[8:11], s31 offen offset:2048  lds
  buffer_load_dwordx4 v43, s[8:11], s31 offen offset:3072  lds
  s_add_u32 m0, s30, 114688
  s_add_u32 s31, s31, 128
  buffer_load_dwordx4 v44, s[12:15], s32 offen offset:0  lds
  s_and_b32 s31, s31, 0x7ff
  buffer_load_dwordx4 v45, s[12:15], s32 offen offset:1024  lds
  buffer_load_dwordx4 v46, s[12:15], s32 offen offset:2048  lds
  buffer_load_dwordx4 v47, s[12:15], s32 offen offset:3072  lds
  s_add_u32 m0, s30, 49152
  s_lshl_b32 s32, s31, 12
  buffer_load_dwordx4 v40, s[8:11], s31 offen offset:0  lds
  buffer_load_dwordx4 v41, s[8:11], s31 offen offset:1024  lds
  buffer_load_dwordx4 v42, s[8:11], s31 offen offset:2048  lds
  s_waitcnt vmcnt(11)
  s_barrier
  ds_read_b128 v[216:219], v62 offset:0
  ds_read_b128 v[220:223], v62 offset:2048
  ds_read_b64_tr_b16 v[152:153], v64 offset:16384
  ds_read_b64_tr_b16 v[154:155], v64 offset:17408
  ds_read_b64_tr_b16 v[156:157], v65 offset:16384
  ds_read_b64_tr_b16 v[158:159], v65 offset:17408
  ds_read_b64_tr_b16 v[160:161], v66 offset:16384
  ds_read_b64_tr_b16 v[162:163], v66 offset:17408
  ds_read_b64_tr_b16 v[164:165], v67 offset:16384
  ds_read_b64_tr_b16 v[166:167], v67 offset:17408
  ds_read_b64_tr_b16 v[168:169], v68 offset:16384
  ds_read_b64_tr_b16 v[170:171], v68 offset:17408
  ds_read_b64_tr_b16 v[172:173], v69 offset:16384
L_qp:
  ds_read_b64_tr_b16 v[174:175], v69 offset:17408
  ds_read_b64_tr_b16 v[176:177], v70 offset:16384
  s_waitcnt lgkmcnt(9)
  v_mfma_f32_16x16x32_bf16 v[88:91], v[152:155], v[216:219], v[88:91]
  buffer_load_dwordx4 v43, s[8:11], s31 offen offset:3072  lds
  ds_read_b64_tr_b16 v[178:179], v70 offset:17408
  ds_read_b64_tr_b16 v[180:181], v71 offset:16384
  v_mfma_f32_16x16x32_bf16 v[92:95], v[152:155], v[220:223], v[92:95]
  ds_read_b64_tr_b16 v[182:183], v71 offset:17408
  v_mfma_f32_16x16x32_bf16 v[96:99], v[156:159], v[216:219], v[96:99]
  ds_read_b128 v[224:227], v63 offset:0
  ds_read_b128 v[228:231], v63 offset:2048
  v_mfma_f32_16x16x32_bf16 v[100:103], v[156:159], v[220:223], v[100:103]
  s_waitcnt lgkmcnt(10)
  ds_read_b64_tr_b16 v[184:185], v64 offset:24576
  ds_read_b64_tr_b16 v[186:187], v64 offset:25600
  v_mfma_f32_16x16x32_bf16 v[104:107], v[160:163], v[216:219], v[104:107]
  s_add_u32 m0, s30, 131072
  s_add_u32 s31, s31, 128
  buffer_load_dwordx4 v44, s[12:15], s32 offen offset:0  lds
  ds_read_b64_tr_b16 v[188:189], v65 offset:24576
  v_mfma_f32_16x16x32_bf16 v[108:111], v[160:163], v[220:223], v[108:111]
  ds_read_b64_tr_b16 v[190:191], v65 offset:25600
  v_mfma_f32_16x16x32_bf16 v[112:115], v[164:167], v[216:219], v[112:115]
  ds_read_b64_tr_b16 v[192:193], v66 offset:24576
  v_mfma_f32_16x16x32_bf16 v[116:119], v[164:167], v[220:223], v[116:119]
  s_waitcnt lgkmcnt(11)
  ds_read_b64_tr_b16 v[194:195], v66 offset:25600
  v_mfma_f32_16x16x32_bf16 v[120:123], v[168:171], v[216:219], v[120:123]
  s_and_b32 s31, s31, 0x7ff
  buffer_load_dwordx4 v45, s[12:15], s32 offen offset:1024  lds
  ds_read_b64_tr_b16 v[196:197], v67 offset:24576
  v_mfma_f32_16x16x32_bf16 v[124:127], v[168:171], v[220:223], v[124:127]
  ds_read_b64_tr_b16 v[198:199], v67 offset:25600
  v_mfma_f32_16x16x32_bf16 v[128:131], v[172:175], v[216:219], v[128:131]
  ds_read_b64_tr_b16 v[200:201], v68 offset:24576
  v_mfma_f32_16x16x32_bf16 v[132:135], v[172:175], v[220:223], v[132:135]
  s_waitcnt lgkmcnt(11)
  ds_read_b64_tr_b16 v[202:203], v68 offset:25600
  v_mfma_f32_16x16x32_bf16 v[136:139], v[176:179], v[216:219], v[136:139]
  buffer_load_dwordx4 v46, s[12:15], s32 offen offset:2048  lds
  ds_read_b64_tr_b16 v[204:205], v69 offset:24576
  v_mfma_f32_16x16x32_bf16 v[140:143], v[176:179], v[220:223], v[140:143]
  ds_read_b64_tr_b16 v[206:207], v69 offset:25600
  v_mfma_f32_16x16x32_bf16 v[144:147], v[180:183], v[216:219], v[144:147]
  ds_read_b64_tr_b16 v[208:209], v70 offset:24576
  v_mfma_f32_16x16x32_bf16 v[148:151], v[180:183], v[220:223], v[148:151]
  s_waitcnt lgkmcnt(9)
  ds_read_b64_tr_b16 v[210:211], v70 offset:25600
  v_mfma_f32_16x16x32_bf16 v[88:91], v[184:187], v[224:227], v[88:91]
  buffer_load_dwordx4 v47, s[12:15], s32 offen offset:3072  lds
  ds_read_b64_tr_b16 v[212:213], v71 offset:24576
  v_mfma_f32_16x16x32_bf16 v[92:95], v[184:187], v[228:231], v[92:95]
  ds_read_b64_tr_b16 v[214:215], v71 offset:25600
  v_mfma_f32_16x16x32_bf16 v[96:99], v[188:191], v[224:227], v[96:99]
  s_cmp_eq_u32 s33, 2
  s_cbranch_scc1 L_kvw0
  s_waitcnt vmcnt(8)
L_kvw0:
  s_waitcnt vmcnt(16)
  s_barrier
  ds_read_b128 v[232:235], v62 offset:16384
  ds_read_b128 v[236:239], v62 offset:18432
  v_mfma_f32_16x16x32_bf16 v[100:103], v[188:191], v[228:231], v[100:103]
  s_waitcnt lgkmcnt(10)
  ds_read_b64_tr_b16 v[152:153], v64 offset:32768
  ds_read_b64_tr_b16 v[154:155], v64 offset:33792
  v_mfma_f32_16x16x32_bf16 v[104:107], v[192:195], v[224:227], v[104:107]
  ds_read_b64_tr_b16 v[156:157], v65 offset:32768
  v_mfma_f32_16x16x32_bf16 v[108:111], v[192:195], v[228:231], v[108:111]
  ds_read_b64_tr_b16 v[158:159], v65 offset:33792
  v_mfma_f32_16x16x32_bf16 v[112:115], v[196:199], v[224:227], v[112:115]
  s_add_u32 m0, s30, 65536
  s_lshl_b32 s32, s31, 12
  buffer_load_dwordx4 v40, s[8:11], s31 offen offset:0  lds
  ds_read_b64_tr_b16 v[160:161], v66 offset:32768
  v_mfma_f32_16x16x32_bf16 v[116:119], v[196:199], v[228:231], v[116:119]
  s_waitcnt lgkmcnt(11)
  ds_read_b64_tr_b16 v[162:163], v66 offset:33792
  v_mfma_f32_16x16x32_bf16 v[120:123], v[200:203], v[224:227], v[120:123]
  ds_read_b64_tr_b16 v[164:165], v67 offset:32768
  v_mfma_f32_16x16x32_bf16 v[124:127], v[200:203], v[228:231], v[124:127]
  ds_read_b64_tr_b16 v[166:167], v67 offset:33792
  v_mfma_f32_16x16x32_bf16 v[128:131], v[204:207], v[224:227], v[128:131]
  buffer_load_dwordx4 v41, s[8:11], s31 offen offset:1024  lds
  ds_read_b64_tr_b16 v[168:169], v68 offset:32768
  v_mfma_f32_16x16x32_bf16 v[132:135], v[204:207], v[228:231], v[132:135]
  s_waitcnt lgkmcnt(11)
  ds_read_b64_tr_b16 v[170:171], v68 offset:33792
  v_mfma_f32_16x16x32_bf16 v[136:139], v[208:211], v[224:227], v[136:139]
  ds_read_b64_tr_b16 v[172:173], v69 offset:32768
  v_mfma_f32_16x16x32_bf16 v[140:143], v[208:211], v[228:231], v[140:143]
  v_mfma_f32_16x16x32_bf16 v[144:147], v[212:215], v[224:227], v[144:147]
  buffer_load_dwordx4 v42, s[8:11], s31 offen offset:2048  lds
  v_mfma_f32_16x16x32_bf16 v[148:151], v[212:215], v[228:231], v[148:151]
  ds_read_b64_tr_b16 v[174:175], v69 offset:33792
  ds_read_b64_tr_b16 v[176:177], v70 offset:32768
  s_waitcnt lgkmcnt(9)
  v_mfma_f32_16x16x32_bf16 v[88:91], v[152:155], v[232:235], v[88:91]
  buffer_load_dwordx4 v43, s[8:11], s31 offen offset:3072  lds
  ds_read_b64_tr_b16 v[178:179], v70 offset:33792
  ds_read_b64_tr_b16 v[180:181], v71 offset:32768
  v_mfma_f32_16x16x32_bf16 v[92:95], v[152:155], v[236:239], v[92:95]
  ds_read_b64_tr_b16 v[182:183], v71 offset:33792
  v_mfma_f32_16x16x32_bf16 v[96:99], v[156:159], v[232:235], v[96:99]
  ds_read_b128 v[240:243], v63 offset:16384
  ds_read_b128 v[244:247], v63 offset:18432
  v_mfma_f32_16x16x32_bf16 v[100:103], v[156:159], v[236:239], v[100:103]
  s_waitcnt lgkmcnt(10)
  ds_read_b64_tr_b16 v[184:185], v64 offset:40960
  ds_read_b64_tr_b16 v[186:187], v64 offset:41984
  v_mfma_f32_16x16x32_bf16 v[104:107], v[160:163], v[232:235], v[104:107]
  s_add_u32 m0, s30, 81920
  s_add_u32 s31, s31, 128
  buffer_load_dwordx4 v44, s[12:15], s32 offen offset:0  lds
  ds_read_b64_tr_b16 v[188:189], v65 offset:40960
  v_mfma_f32_16x16x32_bf16 v[108:111], v[160:163], v[236:239], v[108:111]
  ds_read_b64_tr_b16 v[190:191], v65 offset:41984
  v_mfma_f32_16x16x32_bf16 v[112:115], v[164:167], v[232:235], v[112:115]
  ds_read_b64_tr_b16 v[192:193], v66 offset:40960
  v_mfma_f32_16x16x32_bf16 v[116:119], v[164:167], v[236:239], v[116:119]
  s_waitcnt lgkmcnt(11)
  ds_read_b64_tr_b16 v[194:195], v66 offset:41984
  v_mfma_f32_16x16x32_bf16 v[120:123], v[168:171], v[232:235], v[120:123]
  s_and_b32 s31, s31, 0x7ff
  buffer_load_dwordx4 v45, s[12:15], s32 offen offset:1024  lds
  ds_read_b64_tr_b16 v[196:197], v67 offset:40960
  v_mfma_f32_16x16x32_bf16 v[124:127], v[168:171], v[236:239], v[124:127]
  ds_read_b64_tr_b16 v[198:199], v67 offset:41984
  v_mfma_f32_16x16x32_bf16 v[128:131], v[172:175], v[232:235], v[128:131]
  ds_read_b64_tr_b16 v[200:201], v68 offset:40960
  v_mfma_f32_16x16x32_bf16 v[132:135], v[172:175], v[236:239], v[132:135]
  s_waitcnt lgkmcnt(11)
  ds_read_b64_tr_b16 v[202:203], v68 offset:41984
  v_mfma_f32_16x16x32_bf16 v[136:139], v[176:179], v[232:235], v[136:139]
  buffer_load_dwordx4 v46, s[12:15], s32 offen offset:2048  lds
  ds_read_b64_tr_b16 v[204:205], v69 offset:40960
  v_mfma_f32_16x16x32_bf16 v[140:143], v[176:179], v[236:239], v[140:143]
  ds_read_b64_tr_b16 v[206:207], v69 offset:41984
  v_mfma_f32_16x16x32_bf16 v[144:147], v[180:183], v[232:235], v[144:147]
  ds_read_b64_tr_b16 v[208:209], v70 offset:40960
  v_mfma_f32_16x16x32_bf16 v[148:151], v[180:183], v[236:239], v[148:151]
  s_waitcnt lgkmcnt(9)
  ds_read_b64_tr_b16 v[210:211], v70 offset:41984
  v_mfma_f32_16x16x32_bf16 v[88:91], v[184:187], v[240:243], v[88:91]
  buffer_load_dwordx4 v47, s[12:15], s32 offen offset:3072  lds
  ds_read_b64_tr_b16 v[212:213], v71 offset:40960
  v_mfma_f32_16x16x32_bf16 v[92:95], v[184:187], v[244:247], v[92:95]
  ds_read_b64_tr_b16 v[214:215], v71 offset:41984
  v_mfma_f32_16x16x32_bf16 v[96:99], v[188:191], v[240:243], v[96:99]
  s_waitcnt vmcnt(8)
  s_barrier
  ds_read_b128 v[216:219], v62 offset:32768
  ds_read_b128 v[220:223], v62 offset:34816
  v_mfma_f32_16x16x32_bf16 v[100:103], v[188:191], v[244:247], v[100:103]
  s_waitcnt lgkmcnt(10)
  ds_read_b64_tr_b16 v[152:153], v64 offset:49152
  ds_read_b64_tr_b16 v[154:155], v64 offset:50176
  v_mfma_f32_16x16x32_bf16 v[104:107], v[192:195], v[240:243], v[104:107]
  ds_read_b64_tr_b16 v[156:157], v65 offset:49152
  v_mfma_f32_16x16x32_bf16 v[108:111], v[192:195], v[244:247], v[108:111]
  ds_read_b64_tr_b16 v[158:159], v65 offset:50176
  v_mfma_f32_16x16x32_bf16 v[112:115], v[196:199], v[240:243], v[112:115]
  s_add_u32 m0, s30, 16384
  s_lshl_b32 s32, s31, 12
  buffer_load_dwordx4 v40, s[8:11], s31 offen offset:0  lds
  ds_read_b64_tr_b16 v[160:161], v66 offset:49152
  v_mfma_f32_16x16x32_bf16 v[116:119], v[196:199], v[244:247], v[116:119]
  s_waitcnt lgkmcnt(11)
  ds_read_b64_tr_b16 v[162:163], v66 offset:50176
  v_mfma_f32_16x16x32_bf16 v[120:123], v[200:203], v[240:243], v[120:123]
  ds_read_b64_tr_b16 v[164:165], v67 offset:49152
  v_mfma_f32_16x16x32_bf16 v[124:127], v[200:203], v[244:247], v[124:127]
  ds_read_b64_tr_b16 v[166:167], v67 offset:50176
  v_mfma_f32_16x16x32_bf16 v[128:131], v[204:207], v[240:243], v[128:131]
  buffer_load_dwordx4 v41, s[8:11], s31 offen offset:1024  lds
  ds_read_b64_tr_b16 v[168:169], v68 offset:49152
  v_mfma_f32_16x16x32_bf16 v[132:135], v[204:207], v[244:247], v[132:135]
  s_waitcnt lgkmcnt(11)
  ds_read_b64_tr_b16 v[170:171], v68 offset:50176
  v_mfma_f32_16x16x32_bf16 v[136:139], v[208:211], v[240:243], v[136:139]
  ds_read_b64_tr_b16 v[172:173], v69 offset:49152
  v_mfma_f32_16x16x32_bf16 v[140:143], v[208:211], v[244:247], v[140:143]
  v_mfma_f32_16x16x32_bf16 v[144:147], v[212:215], v[240:243], v[144:147]
  buffer_load_dwordx4 v42, s[8:11], s31 offen offset:2048  lds
  v_mfma_f32_16x16x32_bf16 v[148:151], v[212:215], v[244:247], v[148:151]
  ds_read_b64_tr_b16 v[174:175], v69 offset:50176
  ds_read_b64_tr_b16 v[176:177], v70 offset:49152
  s_waitcnt lgkmcnt(9)
  v_mfma_f32_16x16x32_bf16 v[88:91], v[152:155], v[216:219], v[88:91]
  buffer_load_dwordx4 v43, s[8:11], s31 offen offset:3072  lds
  ds_read_b64_tr_b16 v[178:179], v70 offset:50176
  ds_read_b64_tr_b16 v[180:181], v71 offset:49152
  v_mfma_f32_16x16x32_bf16 v[92:95], v[152:155], v[220:223], v[92:95]
  ds_read_b64_tr_b16 v[182:183], v71 offset:50176
  v_mfma_f32_16x16x32_bf16 v[96:99], v[156:159], v[216:219], v[96:99]
  ds_read_b128 v[224:227], v63 offset:32768
  ds_read_b128 v[228:231], v63 offset:34816
  v_mfma_f32_16x16x32_bf16 v[100:103], v[156:159], v[220:223], v[100:103]
  s_waitcnt lgkmcnt(10)
  ds_read_b64_tr_b16 v[184:185], v64 offset:57344
  ds_read_b64_tr_b16 v[186:187], v64 offset:58368
  v_mfma_f32_16x16x32_bf16 v[104:107], v[160:163], v[216:219], v[104:107]
  s_add_u32 m0, s30, 98304
  s_add_u32 s31, s31, 128
  buffer_load_dwordx4 v44, s[12:15], s32 offen offset:0  lds
  ds_read_b64_tr_b16 v[188:189], v65 offset:57344
  v_mfma_f32_16x16x32_bf16 v[108:111], v[160:163], v[220:223], v[108:111]
  ds_read_b64_tr_b16 v[190:191], v65 offset:58368
  v_mfma_f32_16x16x32_bf16 v[112:115], v[164:167], v[216:219], v[112:115]
  ds_read_b64_tr_b16 v[192:193], v66 offset:57344
  v_mfma_f32_16x16x32_bf16 v[116:119], v[164:167], v[220:223], v[116:119]
  s_waitcnt lgkmcnt(11)
  ds_read_b64_tr_b16 v[194:195], v66 offset:58368
  v_mfma_f32_16x16x32_bf16 v[120:123], v[168:171], v[216:219], v[120:123]
  s_and_b32 s31, s31, 0x7ff
  buffer_load_dwordx4 v45, s[12:15], s32 offen offset:1024  lds
  ds_read_b64_tr_b16 v[196:197], v67 offset:57344
  v_mfma_f32_16x16x32_bf16 v[124:127], v[168:171], v[220:223], v[124:127]
  ds_read_b64_tr_b16 v[198:199], v67 offset:58368
  v_mfma_f32_16x16x32_bf16 v[128:131], v[172:175], v[216:219], v[128:131]
  ds_read_b64_tr_b16 v[200:201], v68 offset:57344
  v_mfma_f32_16x16x32_bf16 v[132:135], v[172:175], v[220:223], v[132:135]
  s_waitcnt lgkmcnt(11)
  ds_read_b64_tr_b16 v[202:203], v68 offset:58368
  v_mfma_f32_16x16x32_bf16 v[136:139], v[176:179], v[216:219], v[136:139]
  buffer_load_dwordx4 v46, s[12:15], s32 offen offset:2048  lds
  ds_read_b64_tr_b16 v[204:205], v69 offset:57344
  v_mfma_f32_16x16x32_bf16 v[140:143], v[176:179], v[220:223], v[140:143]
  ds_read_b64_tr_b16 v[206:207], v69 offset:58368
  v_mfma_f32_16x16x32_bf16 v[144:147], v[180:183], v[216:219], v[144:147]
  ds_read_b64_tr_b16 v[208:209], v70 offset:57344
  v_mfma_f32_16x16x32_bf16 v[148:151], v[180:183], v[220:223], v[148:151]
  s_waitcnt lgkmcnt(9)
  ds_read_b64_tr_b16 v[210:211], v70 offset:58368
  v_mfma_f32_16x16x32_bf16 v[88:91], v[184:187], v[224:227], v[88:91]
  buffer_load_dwordx4 v47, s[12:15], s32 offen offset:3072  lds
  ds_read_b64_tr_b16 v[212:213], v71 offset:57344
  v_mfma_f32_16x16x32_bf16 v[92:95], v[184:187], v[228:231], v[92:95]
  ds_read_b64_tr_b16 v[214:215], v71 offset:58368
  v_mfma_f32_16x16x32_bf16 v[96:99], v[188:191], v[224:227], v[96:99]
  s_waitcnt vmcnt(8)
  s_barrier
  ds_read_b128 v[232:235], v62 offset:49152
  ds_read_b128 v[236:239], v62 offset:51200
  v_mfma_f32_16x16x32_bf16 v[100:103], v[188:191], v[228:231], v[100:103]
  s_waitcnt lgkmcnt(10)
  ds_read_b64_tr_b16 v[152:153], v64 offset:0
  ds_read_b64_tr_b16 v[154:155], v64 offset:1024
  v_mfma_f32_16x16x32_bf16 v[104:107], v[192:195], v[224:227], v[104:107]
  ds_read_b64_tr_b16 v[156:157], v65 offset:0
  v_mfma_f32_16x16x32_bf16 v[108:111], v[192:195], v[228:231], v[108:111]
  ds_read_b64_tr_b16 v[158:159], v65 offset:1024
  v_mfma_f32_16x16x32_bf16 v[112:115], v[196:199], v[224:227], v[112:115]
  s_add_u32 m0, s30, 32768
  s_lshl_b32 s32, s31, 12
  buffer_load_dwordx4 v40, s[8:11], s31 offen offset:0  lds
  ds_read_b64_tr_b16 v[160:161], v66 offset:0
  v_mfma_f32_16x16x32_bf16 v[116:119], v[196:199], v[228:231], v[116:119]
  s_waitcnt lgkmcnt(11)
  ds_read_b64_tr_b16 v[162:163], v66 offset:1024
  v_mfma_f32_16x16x32_bf16 v[120:123], v[200:203], v[224:227], v[120:123]
  ds_read_b64_tr_b16 v[164:165], v67 offset:0
  v_mfma_f32_16x16x32_bf16 v[124:127], v[200:203], v[228:231], v[124:127]
  ds_read_b64_tr_b16 v[166:167], v67 offset:1024
  v_mfma_f32_16x16x32_bf16 v[128:131], v[204:207], v[224:227], v[128:131]
  buffer_load_dwordx4 v41, s[8:11], s31 offen offset:1024  lds
  ds_read_b64_tr_b16 v[168:169], v68 offset:0
  v_mfma_f32_16x16x32_bf16 v[132:135], v[204:207], v[228:231], v[132:135]
  s_waitcnt lgkmcnt(11)
  ds_read_b64_tr_b16 v[170:171], v68 offset:1024
  v_mfma_f32_16x16x32_bf16 v[136:139], v[208:211], v[224:227], v[136:139]
  ds_read_b64_tr_b16 v[172:173], v69 offset:0
  v_mfma_f32_16x16x32_bf16 v[140:143], v[208:211], v[228:231], v[140:143]
  v_mfma_f32_16x16x32_bf16 v[144:147], v[212:215], v[224:227], v[144:147]
  buffer_load_dwordx4 v42, s[8:11], s31 offen offset:2048  lds
  v_mfma_f32_16x16x32_bf16 v[148:151], v[212:215], v[228:231], v[148:151]
  s_or_b32 s3, s29, s33
  s_cbranch_scc1 L_noinit
  v_mov_b32 v38, 1
  v_mov_b32 v39, 0
  s_mov_b64 exec, 1
  buffer_atomic_add v38, v39, s[64:67], 0 offen sc1
  s_mov_b64 exec, s[78:79]
L_noinit:
  ds_read_b64_tr_b16 v[174:175], v69 offset:1024
  ds_read_b64_tr_b16 v[176:177], v70 offset:0
  s_waitcnt lgkmcnt(9)
  v_mfma_f32_16x16x32_bf16 v[88:91], v[152:155], v[232:235], v[88:91]
  buffer_load_dwordx4 v43, s[8:11], s31 offen offset:3072  lds
  ds_read_b64_tr_b16 v[178:179], v70 offset:1024
  ds_read_b64_tr_b16 v[180:181], v71 offset:0
  v_mfma_f32_16x16x32_bf16 v[92:95], v[152:155], v[236:239], v[92:95]
  ds_read_b64_tr_b16 v[182:183], v71 offset:1024
  v_mfma_f32_16x16x32_bf16 v[96:99], v[156:159], v[232:235], v[96:99]
  ds_read_b128 v[240:243], v63 offset:49152
  ds_read_b128 v[244:247], v63 offset:51200
  v_mfma_f32_16x16x32_bf16 v[100:103], v[156:159], v[236:239], v[100:103]
  s_waitcnt lgkmcnt(10)
  ds_read_b64_tr_b16 v[184:185], v64 offset:8192
  ds_read_b64_tr_b16 v[186:187], v64 offset:9216
  v_mfma_f32_16x16x32_bf16 v[104:107], v[160:163], v[232:235], v[104:107]
  s_add_u32 m0, s30, 114688
  s_add_u32 s31, s31, 128
  buffer_load_dwordx4 v44, s[12:15], s32 offen offset:0  lds
  ds_read_b64_tr_b16 v[188:189], v65 offset:8192
  v_mfma_f32_16x16x32_bf16 v[108:111], v[160:163], v[236:239], v[108:111]
  ds_read_b64_tr_b16 v[190:191], v65 offset:9216
  v_mfma_f32_16x16x32_bf16 v[112:115], v[164:167], v[232:235], v[112:115]
  ds_read_b64_tr_b16 v[192:193], v66 offset:8192
  v_mfma_f32_16x16x32_bf16 v[116:119], v[164:167], v[236:239], v[116:119]
  s_waitcnt lgkmcnt(11)
  ds_read_b64_tr_b16 v[194:195], v66 offset:9216
  v_mfma_f32_16x16x32_bf16 v[120:123], v[168:171], v[232:235], v[120:123]
  s_and_b32 s31, s31, 0x7ff
  buffer_load_dwordx4 v45, s[12:15], s32 offen offset:1024  lds
  ds_read_b64_tr_b16 v[196:197], v67 offset:8192
  v_mfma_f32_16x16x32_bf16 v[124:127], v[168:171], v[236:239], v[124:127]
  ds_read_b64_tr_b16 v[198:199], v67 offset:9216
  v_mfma_f32_16x16x32_bf16 v[128:131], v[172:175], v[232:235], v[128:131]
  ds_read_b64_tr_b16 v[200:201], v68 offset:8192
  v_mfma_f32_16x16x32_bf16 v[132:135], v[172:175], v[236:239], v[132:135]
  s_waitcnt lgkmcnt(11)
  ds_read_b64_tr_b16 v[202:203], v68 offset:9216
  v_mfma_f32_16x16x32_bf16 v[136:139], v[176:179], v[232:235], v[136:139]
  buffer_load_dwordx4 v46, s[12:15], s32 offen offset:2048  lds
  ds_read_b64_tr_b16 v[204:205], v69 offset:8192
  v_mfma_f32_16x16x32_bf16 v[140:143], v[176:179], v[236:239], v[140:143]
  ds_read_b64_tr_b16 v[206:207], v69 offset:9216
  v_mfma_f32_16x16x32_bf16 v[144:147], v[180:183], v[232:235], v[144:147]
  ds_read_b64_tr_b16 v[208:209], v70 offset:8192
  v_mfma_f32_16x16x32_bf16 v[148:151], v[180:183], v[236:239], v[148:151]
  s_waitcnt lgkmcnt(9)
  ds_read_b64_tr_b16 v[210:211], v70 offset:9216
  v_mfma_f32_16x16x32_bf16 v[88:91], v[184:187], v[240:243], v[88:91]
  buffer_load_dwordx4 v47, s[12:15], s32 offen offset:3072  lds
  ds_read_b64_tr_b16 v[212:213], v71 offset:8192
  v_mfma_f32_16x16x32_bf16 v[92:95], v[184:187], v[244:247], v[92:95]
  ds_read_b64_tr_b16 v[214:215], v71 offset:9216
  v_mfma_f32_16x16x32_bf16 v[96:99], v[188:191], v[240:243], v[96:99]
  s_waitcnt vmcnt(8)
  s_barrier
  ds_read_b128 v[216:219], v62 offset:0
  ds_read_b128 v[220:223], v62 offset:2048
  v_mfma_f32_16x16x32_bf16 v[100:103], v[188:191], v[244:247], v[100:103]
  s_waitcnt lgkmcnt(10)
  ds_read_b64_tr_b16 v[152:153], v64 offset:16384
  ds_read_b64_tr_b16 v[154:155], v64 offset:17408
  v_mfma_f32_16x16x32_bf16 v[104:107], v[192:195], v[240:243], v[104:107]
  ds_read_b64_tr_b16 v[156:157], v65 offset:16384
  v_mfma_f32_16x16x32_bf16 v[108:111], v[192:195], v[244:247], v[108:111]
  ds_read_b64_tr_b16 v[158:159], v65 offset:17408
  v_mfma_f32_16x16x32_bf16 v[112:115], v[196:199], v[240:243], v[112:115]
  s_add_u32 m0, s30, 49152
  s_lshl_b32 s32, s31, 12
  buffer_load_dwordx4 v40, s[8:11], s31 offen offset:0  lds
  ds_read_b64_tr_b16 v[160:161], v66 offset:16384
  v_mfma_f32_16x16x32_bf16 v[116:119], v[196:199], v[244:247], v[116:119]
  s_waitcnt lgkmcnt(11)
  ds_read_b64_tr_b16 v[162:163], v66 offset:17408
  v_mfma_f32_16x16x32_bf16 v[120:123], v[200:203], v[240:243], v[120:123]
  ds_read_b64_tr_b16 v[164:165], v67 offset:16384
  v_mfma_f32_16x16x32_bf16 v[124:127], v[200:203], v[244:247], v[124:127]
  ds_read_b64_tr_b16 v[166:167], v67 offset:17408
  v_mfma_f32_16x16x32_bf16 v[128:131], v[204:207], v[240:243], v[128:131]
  buffer_load_dwordx4 v41, s[8:11], s31 offen offset:1024  lds
  ds_read_b64_tr_b16 v[168:169], v68 offset:16384
  v_mfma_f32_16x16x32_bf16 v[132:135], v[204:207], v[244:247], v[132:135]
  s_waitcnt lgkmcnt(11)
  ds_read_b64_tr_b16 v[170:171], v68 offset:17408
  v_mfma_f32_16x16x32_bf16 v[136:139], v[208:211], v[240:243], v[136:139]
  ds_read_b64_tr_b16 v[172:173], v69 offset:16384
  v_mfma_f32_16x16x32_bf16 v[140:143], v[208:211], v[244:247], v[140:143]
  v_mfma_f32_16x16x32_bf16 v[144:147], v[212:215], v[240:243], v[144:147]
  buffer_load_dwordx4 v42, s[8:11], s31 offen offset:2048  lds
  v_mfma_f32_16x16x32_bf16 v[148:151], v[212:215], v[244:247], v[148:151]
  s_add_u32 s33, s33, 1
  s_cmp_lt_u32 s33, 3
  s_cmp_lg_u32 s33, 2
  s_cbranch_scc1 L_nox7
  s_add_u32 m0, s30, 0
  s_cmp_lt_u32 s49, 0x80000
  s_cselect_b32 s18, 0x80000, 0
  buffer_load_dwordx4 v10, s[16:19], s49 offen offset:0 nt lds
  buffer_load_dwordx4 v10, s[16:19], s49 offen offset:1024 nt lds
  buffer_load_dwordx4 v11, s[16:19], s49 offen offset:2048 nt lds
  buffer_load_dwordx4 v11, s[16:19], s49 offen offset:3072 nt lds
  s_add_u32 s49, s49, 0x4000
  s_add_u32 m0, s30, 147456
  s_cmp_lt_u32 s50, 0x80000
  s_cselect_b32 s22, 0x80000, 0
  buffer_load_dwordx4 v12, s[20:23], s50 offen offset:0 nt lds
  buffer_load_dwordx4 v12, s[20:23], s50 offen offset:1024 nt lds
  buffer_load_dwordx4 v13, s[20:23], s50 offen offset:2048 nt lds
  buffer_load_dwordx4 v13, s[20:23], s50 offen offset:3072 nt lds
  s_add_u32 s50, s50, 0x4000
  s_add_u32 m0, s30, 49152
L_nox7:
  s_cmp_lt_u32 s33, 3
  s_cbranch_scc1 L_qp
  ds_read_b64_tr_b16 v[174:175], v69 offset:17408
  ds_read_b64_tr_b16 v[176:177], v70 offset:16384
  s_waitcnt lgkmcnt(9)
  v_mfma_f32_16x16x32_bf16 v[88:91], v[152:155], v[216:219], v[88:91]
  buffer_load_dwordx4 v43, s[8:11], s31 offen offset:3072  lds
  ds_read_b64_tr_b16 v[178:179], v70 offset:17408
  ds_read_b64_tr_b16 v[180:181], v71 offset:16384
  v_mfma_f32_16x16x32_bf16 v[92:95], v[152:155], v[220:223], v[92:95]
  ds_read_b64_tr_b16 v[182:183], v71 offset:17408
  v_mfma_f32_16x16x32_bf16 v[96:99], v[156:159], v[216:219], v[96:99]
  ds_read_b128 v[224:227], v63 offset:0
  ds_read_b128 v[228:231], v63 offset:2048
  v_mfma_f32_16x16x32_bf16 v[100:103], v[156:159], v[220:223], v[100:103]
  s_waitcnt lgkmcnt(10)
  ds_read_b64_tr_b16 v[184:185], v64 offset:24576
  ds_read_b64_tr_b16 v[186:187], v64 offset:25600
  v_mfma_f32_16x16x32_bf16 v[104:107], v[160:163], v[216:219], v[104:107]
  s_add_u32 m0, s30, 131072
  s_add_u32 s31, s31, 128
  buffer_load_dwordx4 v44, s[12:15], s32 offen offset:0  lds
  ds_read_b64_tr_b16 v[188:189], v65 offset:24576
  v_mfma_f32_16x16x32_bf16 v[108:111], v[160:163], v[220:223], v[108:111]
  ds_read_b64_tr_b16 v[190:191], v65 offset:25600
  v_mfma_f32_16x16x32_bf16 v[112:115], v[164:167], v[216:219], v[112:115]
  ds_read_b64_tr_b16 v[192:193], v66 offset:24576
  v_mfma_f32_16x16x32_bf16 v[116:119], v[164:167], v[220:223], v[116:119]
  s_waitcnt lgkmcnt(11)
  ds_read_b64_tr_b16 v[194:195], v66 offset:25600
  v_mfma_f32_16x16x32_bf16 v[120:123], v[168:171], v[216:219], v[120:123]
  s_and_b32 s31, s31, 0x7ff
  buffer_load_dwordx4 v45, s[12:15], s32 offen offset:1024  lds
  ds_read_b64_tr_b16 v[196:197], v67 offset:24576
  v_mfma_f32_16x16x32_bf16 v[124:127], v[168:171], v[220:223], v[124:127]
  ds_read_b64_tr_b16 v[198:199], v67 offset:25600
  v_mfma_f32_16x16x32_bf16 v[128:131], v[172:175], v[216:219], v[128:131]
  ds_read_b64_tr_b16 v[200:201], v68 offset:24576
  v_mfma_f32_16x16x32_bf16 v[132:135], v[172:175], v[220:223], v[132:135]
  s_waitcnt lgkmcnt(11)
  ds_read_b64_tr_b16 v[202:203], v68 offset:25600
  v_mfma_f32_16x16x32_bf16 v[136:139], v[176:179], v[216:219], v[136:139]
  buffer_load_dwordx4 v46, s[12:15], s32 offen offset:2048  lds
  ds_read_b64_tr_b16 v[204:205], v69 offset:24576
  v_mfma_f32_16x16x32_bf16 v[140:143], v[176:179], v[220:223], v[140:143]
  ds_read_b64_tr_b16 v[206:207], v69 offset:25600
  v_mfma_f32_16x16x32_bf16 v[144:147], v[180:183], v[216:219], v[144:147]
  ds_read_b64_tr_b16 v[208:209], v70 offset:24576
  v_mfma_f32_16x16x32_bf16 v[148:151], v[180:183], v[220:223], v[148:151]
  s_waitcnt lgkmcnt(9)
  ds_read_b64_tr_b16 v[210:211], v70 offset:25600
  v_mfma_f32_16x16x32_bf16 v[88:91], v[184:187], v[224:227], v[88:91]
  buffer_load_dwordx4 v47, s[12:15], s32 offen offset:3072  lds
  ds_read_b64_tr_b16 v[212:213], v71 offset:24576
  v_mfma_f32_16x16x32_bf16 v[92:95], v[184:187], v[228:231], v[92:95]
  ds_read_b64_tr_b16 v[214:215], v71 offset:25600
  v_mfma_f32_16x16x32_bf16 v[96:99], v[188:191], v[224:227], v[96:99]
  s_waitcnt vmcnt(8)
  s_barrier
  ds_read_b128 v[232:235], v62 offset:16384
  ds_read_b128 v[236:239], v62 offset:18432
  v_mfma_f32_16x16x32_bf16 v[100:103], v[188:191], v[228:231], v[100:103]
  s_waitcnt lgkmcnt(10)
  ds_read_b64_tr_b16 v[152:153], v64 offset:32768
  ds_read_b64_tr_b16 v[154:155], v64 offset:33792
  v_mfma_f32_16x16x32_bf16 v[104:107], v[192:195], v[224:227], v[104:107]
  ds_read_b64_tr_b16 v[156:157], v65 offset:32768
  v_mfma_f32_16x16x32_bf16 v[108:111], v[192:195], v[228:231], v[108:111]
  ds_read_b64_tr_b16 v[158:159], v65 offset:33792
  v_mfma_f32_16x16x32_bf16 v[112:115], v[196:199], v[224:227], v[112:115]
  s_add_u32 m0, s30, 65536
  s_lshl_b32 s32, s31, 12
  buffer_load_dwordx4 v40, s[8:11], s31 offen offset:0  lds
  ds_read_b64_tr_b16 v[160:161], v66 offset:32768
  v_mfma_f32_16x16x32_bf16 v[116:119], v[196:199], v[228:231], v[116:119]
  s_waitcnt lgkmcnt(11)
  ds_read_b64_tr_b16 v[162:163], v66 offset:33792
  v_mfma_f32_16x16x32_bf16 v[120:123], v[200:203], v[224:227], v[120:123]
  ds_read_b64_tr_b16 v[164:165], v67 offset:32768
  v_mfma_f32_16x16x32_bf16 v[124:127], v[200:203], v[228:231], v[124:127]
  ds_read_b64_tr_b16 v[166:167], v67 offset:33792
  v_mfma_f32_16x16x32_bf16 v[128:131], v[204:207], v[224:227], v[128:131]
  buffer_load_dwordx4 v41, s[8:11], s31 offen offset:1024  lds
  ds_read_b64_tr_b16 v[168:169], v68 offset:32768
  v_mfma_f32_16x16x32_bf16 v[132:135], v[204:207], v[228:231], v[132:135]
  s_waitcnt lgkmcnt(11)
  ds_read_b64_tr_b16 v[170:171], v68 offset:33792
  v_mfma_f32_16x16x32_bf16 v[136:139], v[208:211], v[224:227], v[136:139]
  ds_read_b64_tr_b16 v[172:173], v69 offset:32768
  v_mfma_f32_16x16x32_bf16 v[140:143], v[208:211], v[228:231], v[140:143]
  v_mfma_f32_16x16x32_bf16 v[144:147], v[212:215], v[224:227], v[144:147]
  buffer_load_dwordx4 v42, s[8:11], s31 offen offset:2048  lds
  v_mfma_f32_16x16x32_bf16 v[148:151], v[212:215], v[228:231], v[148:151]
  ds_read_b64_tr_b16 v[174:175], v69 offset:33792
  ds_read_b64_tr_b16 v[176:177], v70 offset:32768
  s_waitcnt lgkmcnt(9)
  v_mfma_f32_16x16x32_bf16 v[88:91], v[152:155], v[232:235], v[88:91]
  buffer_load_dwordx4 v43, s[8:11], s31 offen offset:3072  lds
  ds_read_b64_tr_b16 v[178:179], v70 offset:33792
  ds_read_b64_tr_b16 v[180:181], v71 offset:32768
  v_mfma_f32_16x16x32_bf16 v[92:95], v[152:155], v[236:239], v[92:95]
  ds_read_b64_tr_b16 v[182:183], v71 offset:33792
  v_mfma_f32_16x16x32_bf16 v[96:99], v[156:159], v[232:235], v[96:99]
  ds_read_b128 v[240:243], v63 offset:16384
  ds_read_b128 v[244:247], v63 offset:18432
  v_mfma_f32_16x16x32_bf16 v[100:103], v[156:159], v[236:239], v[100:103]
  s_waitcnt lgkmcnt(10)
  ds_read_b64_tr_b16 v[184:185], v64 offset:40960
  ds_read_b64_tr_b16 v[186:187], v64 offset:41984
  v_mfma_f32_16x16x32_bf16 v[104:107], v[160:163], v[232:235], v[104:107]
  s_add_u32 m0, s30, 81920
  s_add_u32 s31, s31, 128
  buffer_load_dwordx4 v44, s[12:15], s32 offen offset:0  lds
  ds_read_b64_tr_b16 v[188:189], v65 offset:40960
  v_mfma_f32_16x16x32_bf16 v[108:111], v[160:163], v[236:239], v[108:111]
  ds_read_b64_tr_b16 v[190:191], v65 offset:41984
  v_mfma_f32_16x16x32_bf16 v[112:115], v[164:167], v[232:235], v[112:115]
  ds_read_b64_tr_b16 v[192:193], v66 offset:40960
  v_mfma_f32_16x16x32_bf16 v[116:119], v[164:167], v[236:239], v[116:119]
  s_waitcnt lgkmcnt(11)
  ds_read_b64_tr_b16 v[194:195], v66 offset:41984
  v_mfma_f32_16x16x32_bf16 v[120:123], v[168:171], v[232:235], v[120:123]
  s_and_b32 s31, s31, 0x7ff
  buffer_load_dwordx4 v45, s[12:15], s32 offen offset:1024  lds
  ds_read_b64_tr_b16 v[196:197], v67 offset:40960
  v_mfma_f32_16x16x32_bf16 v[124:127], v[168:171], v[236:239], v[124:127]
  ds_read_b64_tr_b16 v[198:199], v67 offset:41984
  v_mfma_f32_16x16x32_bf16 v[128:131], v[172:175], v[232:235], v[128:131]
  ds_read_b64_tr_b16 v[200:201], v68 offset:40960
  v_mfma_f32_16x16x32_bf16 v[132:135], v[172:175], v[236:239], v[132:135]
  s_waitcnt lgkmcnt(11)
  ds_read_b64_tr_b16 v[202:203], v68 offset:41984
  v_mfma_f32_16x16x32_bf16 v[136:139], v[176:179], v[232:235], v[136:139]
  buffer_load_dwordx4 v46, s[12:15], s32 offen offset:2048  lds
  ds_read_b64_tr_b16 v[204:205], v69 offset:40960
  v_mfma_f32_16x16x32_bf16 v[140:143], v[176:179], v[236:239], v[140:143]
  ds_read_b64_tr_b16 v[206:207], v69 offset:41984
  v_mfma_f32_16x16x32_bf16 v[144:147], v[180:183], v[232:235], v[144:147]
  ds_read_b64_tr_b16 v[208:209], v70 offset:40960
  v_mfma_f32_16x16x32_bf16 v[148:151], v[180:183], v[236:239], v[148:151]
  s_waitcnt lgkmcnt(9)
  ds_read_b64_tr_b16 v[210:211], v70 offset:41984
  v_mfma_f32_16x16x32_bf16 v[88:91], v[184:187], v[240:243], v[88:91]
  buffer_load_dwordx4 v47, s[12:15], s32 offen offset:3072  lds
  ds_read_b64_tr_b16 v[212:213], v71 offset:40960
  v_mfma_f32_16x16x32_bf16 v[92:95], v[184:187], v[244:247], v[92:95]
  ds_read_b64_tr_b16 v[214:215], v71 offset:41984
  v_mfma_f32_16x16x32_bf16 v[96:99], v[188:191], v[240:243], v[96:99]
  s_waitcnt vmcnt(8)
  s_barrier
  ds_read_b128 v[216:219], v62 offset:32768
  ds_read_b128 v[220:223], v62 offset:34816
  v_mfma_f32_16x16x32_bf16 v[100:103], v[188:191], v[244:247], v[100:103]
  s_waitcnt lgkmcnt(10)
  ds_read_b64_tr_b16 v[152:153], v64 offset:49152
  ds_read_b64_tr_b16 v[154:155], v64 offset:50176
  v_mfma_f32_16x16x32_bf16 v[104:107], v[192:195], v[240:243], v[104:107]
  ds_read_b64_tr_b16 v[156:157], v65 offset:49152
  v_mfma_f32_16x16x32_bf16 v[108:111], v[192:195], v[244:247], v[108:111]
  ds_read_b64_tr_b16 v[158:159], v65 offset:50176
  v_mfma_f32_16x16x32_bf16 v[112:115], v[196:199], v[240:243], v[112:115]
  s_add_u32 m0, s30, 16384
  s_cmp_lt_u32 s49, 0x80000
  s_cselect_b32 s18, 0x80000, 0
  buffer_load_dwordx4 v10, s[16:19], s49 offen offset:0 nt lds
  ds_read_b64_tr_b16 v[160:161], v66 offset:49152
  v_mfma_f32_16x16x32_bf16 v[116:119], v[196:199], v[244:247], v[116:119]
  s_waitcnt lgkmcnt(11)
  ds_read_b64_tr_b16 v[162:163], v66 offset:50176
  v_mfma_f32_16x16x32_bf16 v[120:123], v[200:203], v[240:243], v[120:123]
  ds_read_b64_tr_b16 v[164:165], v67 offset:49152
  v_mfma_f32_16x16x32_bf16 v[124:127], v[200:203], v[244:247], v[124:127]
  ds_read_b64_tr_b16 v[166:167], v67 offset:50176
  v_mfma_f32_16x16x32_bf16 v[128:131], v[204:207], v[240:243], v[128:131]
  buffer_load_dwordx4 v10, s[16:19], s49 offen offset:1024 nt lds
  ds_read_b64_tr_b16 v[168:169], v68 offset:49152
  v_mfma_f32_16x16x32_bf16 v[132:135], v[204:207], v[244:247], v[132:135]
  s_waitcnt lgkmcnt(11)
  ds_read_b64_tr_b16 v[170:171], v68 offset:50176
  v_mfma_f32_16x16x32_bf16 v[136:139], v[208:211], v[240:243], v[136:139]
  ds_read_b64_tr_b16 v[172:173], v69 offset:49152
  v_mfma_f32_16x16x32_bf16 v[140:143], v[208:211], v[244:247], v[140:143]
  v_mfma_f32_16x16x32_bf16 v[144:147], v[212:215], v[240:243], v[144:147]
  buffer_load_dwordx4 v11, s[16:19], s49 offen offset:2048 nt lds
  v_mfma_f32_16x16x32_bf16 v[148:151], v[212:215], v[244:247], v[148:151]
  ds_read_b64_tr_b16 v[174:175], v69 offset:50176
  ds_read_b64_tr_b16 v[176:177], v70 offset:49152
  s_waitcnt lgkmcnt(9)
  v_mfma_f32_16x16x32_bf16 v[88:91], v[152:155], v[216:219], v[88:91]
  buffer_load_dwordx4 v11, s[16:19], s49 offen offset:3072 nt lds
  ds_read_b64_tr_b16 v[178:179], v70 offset:50176
  ds_read_b64_tr_b16 v[180:181], v71 offset:49152
  v_mfma_f32_16x16x32_bf16 v[92:95], v[152:155], v[220:223], v[92:95]
  ds_read_b64_tr_b16 v[182:183], v71 offset:50176
  v_mfma_f32_16x16x32_bf16 v[96:99], v[156:159], v[216:219], v[96:99]
  ds_read_b128 v[224:227], v63 offset:32768
  ds_read_b128 v[228:231], v63 offset:34816
  v_mfma_f32_16x16x32_bf16 v[100:103], v[156:159], v[220:223], v[100:103]
  s_waitcnt lgkmcnt(10)
  ds_read_b64_tr_b16 v[184:185], v64 offset:57344
  ds_read_b64_tr_b16 v[186:187], v64 offset:58368
  v_mfma_f32_16x16x32_bf16 v[104:107], v[160:163], v[216:219], v[104:107]
  s_add_u32 s49, s49, 0x4000
  s_add_u32 m0, s30, 98304
  s_cmp_lt_u32 s50, 0x80000
  s_cselect_b32 s22, 0x80000, 0
  buffer_load_dwordx4 v12, s[20:23], s50 offen offset:0 nt lds
  ds_read_b64_tr_b16 v[188:189], v65 offset:57344
  v_mfma_f32_16x16x32_bf16 v[108:111], v[160:163], v[220:223], v[108:111]
  ds_read_b64_tr_b16 v[190:191], v65 offset:58368
  v_mfma_f32_16x16x32_bf16 v[112:115], v[164:167], v[216:219], v[112:115]
  ds_read_b64_tr_b16 v[192:193], v66 offset:57344
  v_mfma_f32_16x16x32_bf16 v[116:119], v[164:167], v[220:223], v[116:119]
  s_waitcnt lgkmcnt(11)
  ds_read_b64_tr_b16 v[194:195], v66 offset:58368
  v_mfma_f32_16x16x32_bf16 v[120:123], v[168:171], v[216:219], v[120:123]
  buffer_load_dwordx4 v12, s[20:23], s50 offen offset:1024 nt lds
  ds_read_b64_tr_b16 v[196:197], v67 offset:57344
  v_mfma_f32_16x16x32_bf16 v[124:127], v[168:171], v[220:223], v[124:127]
  ds_read_b64_tr_b16 v[198:199], v67 offset:58368
  v_mfma_f32_16x16x32_bf16 v[128:131], v[172:175], v[216:219], v[128:131]
  ds_read_b64_tr_b16 v[200:201], v68 offset:57344
  v_mfma_f32_16x16x32_bf16 v[132:135], v[172:175], v[220:223], v[132:135]
  s_waitcnt lgkmcnt(11)
  ds_read_b64_tr_b16 v[202:203], v68 offset:58368
  v_mfma_f32_16x16x32_bf16 v[136:139], v[176:179], v[216:219], v[136:139]
  buffer_load_dwordx4 v13, s[20:23], s50 offen offset:2048 nt lds
  ds_read_b64_tr_b16 v[204:205], v69 offset:57344
  v_mfma_f32_16x16x32_bf16 v[140:143], v[176:179], v[220:223], v[140:143]
  ds_read_b64_tr_b16 v[206:207], v69 offset:58368
  v_mfma_f32_16x16x32_bf16 v[144:147], v[180:183], v[216:219], v[144:147]
  ds_read_b64_tr_b16 v[208:209], v70 offset:57344
  v_mfma_f32_16x16x32_bf16 v[148:151], v[180:183], v[220:223], v[148:151]
  s_waitcnt lgkmcnt(9)
  ds_read_b64_tr_b16 v[210:211], v70 offset:58368
  v_mfma_f32_16x16x32_bf16 v[88:91], v[184:187], v[224:227], v[88:91]
  buffer_load_dwordx4 v13, s[20:23], s50 offen offset:3072 nt lds
  s_add_u32 s50, s50, 0x4000
  ds_read_b64_tr_b16 v[212:213], v71 offset:57344
  v_mfma_f32_16x16x32_bf16 v[92:95], v[184:187], v[228:231], v[92:95]
  ds_read_b64_tr_b16 v[214:215], v71 offset:58368
  v_mfma_f32_16x16x32_bf16 v[96:99], v[188:191], v[224:227], v[96:99]
  s_waitcnt vmcnt(8)
  s_barrier
  ds_read_b128 v[72:75], v62 offset:49152
  ds_read_b128 v[76:79], v62 offset:51200
  v_mfma_f32_16x16x32_bf16 v[100:103], v[188:191], v[228:231], v[100:103]
  s_waitcnt lgkmcnt(10)
  ds_read_b64_tr_b16 v[152:153], v64 offset:0
  ds_read_b64_tr_b16 v[154:155], v64 offset:1024
  v_mfma_f32_16x16x32_bf16 v[104:107], v[192:195], v[224:227], v[104:107]
  ds_read_b128 v[80:83], v63 offset:49152
  ds_read_b128 v[84:87], v63 offset:51200
  v_mfma_f32_16x16x32_bf16 v[108:111], v[192:195], v[228:231], v[108:111]
  ds_read_b64_tr_b16 v[156:157], v64 offset:8192
  v_mfma_f32_16x16x32_bf16 v[112:115], v[196:199], v[224:227], v[112:115]
  s_add_u32 m0, s30, 32768
  s_cmp_lt_u32 s49, 0x80000
  s_cselect_b32 s18, 0x80000, 0
  buffer_load_dwordx4 v10, s[16:19], s49 offen offset:0 nt lds
  v_mfma_f32_16x16x32_bf16 v[116:119], v[196:199], v[228:231], v[116:119]
  s_waitcnt lgkmcnt(11)
  ds_read_b64_tr_b16 v[158:159], v64 offset:9216
  ds_read_b64_tr_b16 v[160:161], v65 offset:0
  v_mfma_f32_16x16x32_bf16 v[120:123], v[200:203], v[224:227], v[120:123]
  ds_read_b64_tr_b16 v[162:163], v65 offset:1024
  ds_read_b64_tr_b16 v[164:165], v65 offset:8192
  v_mfma_f32_16x16x32_bf16 v[124:127], v[200:203], v[228:231], v[124:127]
  v_mfma_f32_16x16x32_bf16 v[128:131], v[204:207], v[224:227], v[128:131]
  buffer_load_dwordx4 v10, s[16:19], s49 offen offset:1024 nt lds
  v_mfma_f32_16x16x32_bf16 v[132:135], v[204:207], v[228:231], v[132:135]
  s_waitcnt lgkmcnt(11)
  ds_read_b64_tr_b16 v[166:167], v65 offset:9216
  ds_read_b64_tr_b16 v[168:169], v66 offset:0
  v_mfma_f32_16x16x32_bf16 v[136:139], v[208:211], v[224:227], v[136:139]
  v_mfma_f32_16x16x32_bf16 v[140:143], v[208:211], v[228:231], v[140:143]
  v_mfma_f32_16x16x32_bf16 v[144:147], v[212:215], v[224:227], v[144:147]
  buffer_load_dwordx4 v11, s[16:19], s49 offen offset:2048 nt lds
  v_mfma_f32_16x16x32_bf16 v[148:151], v[212:215], v[228:231], v[148:151]
  ds_read_b64_tr_b16 v[170:171], v66 offset:1024
  ds_read_b64_tr_b16 v[172:173], v66 offset:8192
  s_waitcnt lgkmcnt(7)
  v_mfma_f32_16x16x32_bf16 v[88:91], v[152:155], v[72:75], v[88:91]
  buffer_load_dwordx4 v11, s[16:19], s49 offen offset:3072 nt lds
  ds_read_b64_tr_b16 v[174:175], v66 offset:9216
  ds_read_b64_tr_b16 v[176:177], v67 offset:0
  v_mfma_f32_16x16x32_bf16 v[92:95], v[152:155], v[76:79], v[92:95]
  ds_read_b64_tr_b16 v[178:179], v67 offset:1024
  ds_read_b64_tr_b16 v[180:181], v67 offset:8192
  v_mfma_f32_16x16x32_bf16 v[88:91], v[156:159], v[80:83], v[88:91]
  ds_read_b64_tr_b16 v[182:183], v67 offset:9216
  ds_read_b64_tr_b16 v[184:185], v68 offset:0
  v_mfma_f32_16x16x32_bf16 v[92:95], v[156:159], v[84:87], v[92:95]
  s_waitcnt lgkmcnt(9)
  ds_read_b64_tr_b16 v[186:187], v68 offset:1024
  v_mfma_f32_16x16x32_bf16 v[96:99], v[160:163], v[72:75], v[96:99]
  s_add_u32 s49, s49, 0x4000
  s_add_u32 m0, s30, 114688
  s_cmp_lt_u32 s50, 0x80000
  s_cselect_b32 s22, 0x80000, 0
  buffer_load_dwordx4 v12, s[20:23], s50 offen offset:0 nt lds
  ds_read_b64_tr_b16 v[188:189], v68 offset:8192
  v_mfma_f32_16x16x32_bf16 v[100:103], v[160:163], v[76:79], v[100:103]
  ds_read_b64_tr_b16 v[190:191], v68 offset:9216
  v_mfma_f32_16x16x32_bf16 v[96:99], v[164:167], v[80:83], v[96:99]
  ds_read_b64_tr_b16 v[192:193], v69 offset:0
  v_mfma_f32_16x16x32_bf16 v[100:103], v[164:167], v[84:87], v[100:103]
  s_waitcnt lgkmcnt(9)
  ds_read_b64_tr_b16 v[194:195], v69 offset:1024
  v_mfma_f32_16x16x32_bf16 v[104:107], v[168:171], v[72:75], v[104:107]
  buffer_load_dwordx4 v12, s[20:23], s50 offen offset:1024 nt lds
  ds_read_b64_tr_b16 v[196:197], v69 offset:8192
  v_mfma_f32_16x16x32_bf16 v[108:111], v[168:171], v[76:79], v[108:111]
  ds_read_b64_tr_b16 v[198:199], v69 offset:9216
  v_mfma_f32_16x16x32_bf16 v[104:107], v[172:175], v[80:83], v[104:107]
  ds_read_b64_tr_b16 v[200:201], v70 offset:0
  v_mfma_f32_16x16x32_bf16 v[108:111], v[172:175], v[84:87], v[108:111]
  s_waitcnt lgkmcnt(9)
  ds_read_b64_tr_b16 v[202:203], v70 offset:1024
  v_mfma_f32_16x16x32_bf16 v[112:115], v[176:179], v[72:75], v[112:115]
  buffer_load_dwordx4 v13, s[20:23], s50 offen offset:2048 nt lds
  ds_read_b64_tr_b16 v[204:205], v70 offset:8192
  v_pk_mul_f32 v[88:89], v[88:89], s[52:53]
  v_mfma_f32_16x16x32_bf16 v[116:119], v[176:179], v[76:79], v[116:119]
  ds_read_b64_tr_b16 v[206:207], v70 offset:9216
  v_pk_mul_f32 v[90:91], v[90:91], s[52:53]
  v_pk_mul_f32 v[92:93], v[92:93], s[52:53]
  v_mfma_f32_16x16x32_bf16 v[112:115], v[180:183], v[80:83], v[112:115]
  ds_read_b64_tr_b16 v[208:209], v71 offset:0
  v_pk_mul_f32 v[94:95], v[94:95], s[52:53]
  v_pk_mul_f32 v[96:97], v[96:97], s[52:53]
  v_mfma_f32_16x16x32_bf16 v[116:119], v[180:183], v[84:87], v[116:119]
  s_waitcnt lgkmcnt(9)
  ds_read_b64_tr_b16 v[210:211], v71 offset:1024
  v_pk_mul_f32 v[98:99], v[98:99], s[52:53]
  v_mfma_f32_16x16x32_bf16 v[120:123], v[184:187], v[72:75], v[120:123]
  buffer_load_dwordx4 v13, s[20:23], s50 offen offset:3072 nt lds
  s_add_u32 s50, s50, 0x4000
  ds_read_b64_tr_b16 v[212:213], v71 offset:8192
  v_mfma_f32_16x16x32_bf16 v[124:127], v[184:187], v[76:79], v[124:127]
  ds_read_b64_tr_b16 v[214:215], v71 offset:9216
  v_pk_mul_f32 v[100:101], v[100:101], s[52:53]
  v_pk_mul_f32 v[102:103], v[102:103], s[52:53]
  v_mfma_f32_16x16x32_bf16 v[120:123], v[188:191], v[80:83], v[120:123]
  s_barrier
  ds_read_b128 v[216:219], v16 offset:0
  v_cvt_pk_bf16_f32 v40, v88, v89
  v_mfma_f32_16x16x32_bf16 v[124:127], v[188:191], v[84:87], v[124:127]
  s_waitcnt lgkmcnt(9)
  v_cvt_pk_bf16_f32 v41, v90, v91
  v_cvt_pk_bf16_f32 v42, v96, v97
  v_mfma_f32_16x16x32_bf16 v[128:131], v[192:195], v[72:75], v[128:131]
  ds_read_b128 v[220:223], v17 offset:0
  v_cvt_pk_bf16_f32 v43, v98, v99
  v_cvt_pk_bf16_f32 v44, v92, v93
  v_mfma_f32_16x16x32_bf16 v[132:135], v[192:195], v[76:79], v[132:135]
  v_cvt_pk_bf16_f32 v45, v94, v95
  v_cvt_pk_bf16_f32 v46, v100, v101
  v_cvt_pk_bf16_f32 v47, v102, v103
  v_mfma_f32_16x16x32_bf16 v[128:131], v[196:199], v[80:83], v[128:131]
  s_add_u32 m0, s30, 49152
  s_cmp_lt_u32 s49, 0x80000
  s_cselect_b32 s18, 0x80000, 0
  buffer_load_dwordx4 v10, s[16:19], s49 offen offset:0 nt lds
  ds_read_b128 v[224:227], v18 offset:0
  v_mfma_f32_16x16x32_bf16 v[132:135], v[196:199], v[84:87], v[132:135]
  s_waitcnt lgkmcnt(7)
  v_pk_mul_f32 v[104:105], v[104:105], s[52:53]
  v_mfma_f32_16x16x32_bf16 v[136:139], v[200:203], v[72:75], v[136:139]
  ds_read_b128 v[228:231], v19 offset:0
  v_pk_mul_f32 v[106:107], v[106:107], s[52:53]
  v_mfma_f32_16x16x32_bf16 v[140:143], v[200:203], v[76:79], v[140:143]
  v_pk_mul_f32 v[108:109], v[108:109], s[52:53]
  v_pk_mul_f32 v[110:111], v[110:111], s[52:53]
  v_mfma_f32_16x16x32_bf16 v[136:139], v[204:207], v[80:83], v[136:139]
  buffer_load_dwordx4 v10, s[16:19], s49 offen offset:1024 nt lds
  ds_read_b128 v[232:235], v16 offset:1024
  v_mfma_f32_16x16x32_bf16 v[140:143], v[204:207], v[84:87], v[140:143]
  s_waitcnt lgkmcnt(5)
  v_pk_mul_f32 v[112:113], v[112:113], s[52:53]
  v_pk_mul_f32 v[114:115], v[114:115], s[52:53]
  v_mfma_f32_16x16x32_bf16 v[144:147], v[208:211], v[72:75], v[144:147]
  ds_read_b128 v[236:239], v17 offset:1024
  v_pk_mul_f32 v[116:117], v[116:117], s[52:53]
  v_mfma_f32_16x16x32_bf16 v[148:151], v[208:211], v[76:79], v[148:151]
  v_pk_mul_f32 v[118:119], v[118:119], s[52:53]
  v_mfma_f32_16x16x32_bf16 v[144:147], v[212:215], v[80:83], v[144:147]
  buffer_load_dwordx4 v11, s[16:19], s49 offen offset:2048 nt lds
  ds_read_b128 v[240:243], v18 offset:1024
  v_mfma_f32_16x16x32_bf16 v[148:151], v[212:215], v[84:87], v[148:151]
  buffer_load_dwordx4 v11, s[16:19], s49 offen offset:3072 nt lds
  s_add_u32 s49, s49, 0x4000
  v_cvt_pk_bf16_f32 v48, v104, v105
  v_cvt_pk_bf16_f32 v49, v106, v107
  v_cvt_pk_bf16_f32 v50, v112, v113
  v_cvt_pk_bf16_f32 v51, v114, v115
  v_cvt_pk_bf16_f32 v52, v108, v109
  v_cvt_pk_bf16_f32 v53, v110, v111
  v_cvt_pk_bf16_f32 v54, v116, v117
  v_cvt_pk_bf16_f32 v55, v118, v119
  v_permlane16_swap_b32 v40, v42
  v_permlane16_swap_b32 v41, v43
  v_permlane16_swap_b32 v44, v46
  v_permlane16_swap_b32 v45, v47
  v_pk_mul_f32 v[120:121], v[120:121], s[52:53]
  v_pk_mul_f32 v[122:123], v[122:123], s[52:53]
  v_pk_mul_f32 v[124:125], v[124:125], s[52:53]
  v_pk_mul_f32 v[126:127], v[126:127], s[52:53]
  v_pk_mul_f32 v[128:129], v[128:129], s[52:53]
  v_pk_mul_f32 v[130:131], v[130:131], s[52:53]
  v_pk_mul_f32 v[132:133], v[132:133], s[52:53]
  v_pk_mul_f32 v[134:135], v[134:135], s[52:53]
  v_cvt_pk_bf16_f32 v56, v120, v121
  v_cvt_pk_bf16_f32 v57, v122, v123
  v_cvt_pk_bf16_f32 v58, v128, v129
  v_cvt_pk_bf16_f32 v59, v130, v131
  v_cvt_pk_bf16_f32 v60, v124, v125
  v_cvt_pk_bf16_f32 v61, v126, v127
  v_cvt_pk_bf16_f32 v62, v132, v133
  v_cvt_pk_bf16_f32 v63, v134, v135
  v_permlane16_swap_b32 v48, v50
  v_permlane16_swap_b32 v49, v51
  v_permlane16_swap_b32 v52, v54
  v_permlane16_swap_b32 v53, v55
  v_pk_mul_f32 v[136:137], v[136:137], s[52:53]
  v_pk_mul_f32 v[138:139], v[138:139], s[52:53]
  v_pk_mul_f32 v[140:141], v[140:141], s[52:53]
  v_pk_mul_f32 v[142:143], v[142:143], s[52:53]
  v_pk_mul_f32 v[144:145], v[144:145], s[52:53]
  v_pk_mul_f32 v[146:147], v[146:147], s[52:53]
  v_pk_mul_f32 v[148:149], v[148:149], s[52:53]
  v_pk_mul_f32 v[150:151], v[150:151], s[52:53]
  v_cvt_pk_bf16_f32 v64, v136, v137
  v_cvt_pk_bf16_f32 v65, v138, v139
  v_cvt_pk_bf16_f32 v66, v144, v145
  v_cvt_pk_bf16_f32 v67, v146, v147
  v_cvt_pk_bf16_f32 v68, v140, v141
  v_cvt_pk_bf16_f32 v69, v142, v143
  v_cvt_pk_bf16_f32 v70, v148, v149
  v_cvt_pk_bf16_f32 v71, v150, v151
  v_permlane16_swap_b32 v56, v58
  v_permlane16_swap_b32 v57, v59
  v_permlane16_swap_b32 v60, v62
  v_permlane16_swap_b32 v61, v63
  s_nop 0
  v_permlane16_swap_b32 v64, v66
  v_permlane16_swap_b32 v65, v67
  v_permlane16_swap_b32 v68, v70
  v_permlane16_swap_b32 v69, v71
  s_waitcnt lgkmcnt(4)
  v_mfma_f32_16x16x32_bf16 v[88:91], v[216:219], v[40:43], 0
  ds_read_b128 v[244:247], v19 offset:1024
  v_mov_b32 v152, 0
  v_mov_b32 v153, 0
  v_mfma_f32_16x16x32_bf16 v[104:107], v[216:219], v[44:47], 0
  v_mov_b32 v154, 0
  v_mov_b32 v155, 0
  v_mfma_f32_16x16x32_bf16 v[88:91], v[220:223], v[48:51], v[88:91]
  ds_read_b128 v[216:219], v16 offset:8192
  v_mov_b32 v156, 0
  v_mov_b32 v157, 0
  v_mfma_f32_16x16x32_bf16 v[104:107], v[220:223], v[52:55], v[104:107]
  v_mov_b32 v158, 0
  v_mov_b32 v159, 0
  v_mfma_f32_16x16x32_bf16 v[88:91], v[224:227], v[56:59], v[88:91]
  ds_read_b128 v[220:223], v17 offset:8192
  v_mov_b32 v160, 0
  v_mov_b32 v161, 0
  v_mfma_f32_16x16x32_bf16 v[104:107], v[224:227], v[60:63], v[104:107]
  s_waitcnt lgkmcnt(4)
  v_mov_b32 v162, 0
  v_mov_b32 v163, 0
  v_mfma_f32_16x16x32_bf16 v[88:91], v[228:231], v[64:67], v[88:91]
  ds_read_b128 v[224:227], v18 offset:8192
  v_mov_b32 v164, 0
  v_mov_b32 v165, 0
  v_mfma_f32_16x16x32_bf16 v[104:107], v[228:231], v[68:71], v[104:107]
  v_mov_b32 v166, 0
  v_mov_b32 v167, 0
  v_mfma_f32_16x16x32_bf16 v[92:95], v[232:235], v[40:43], 0
  ds_read_b128 v[228:231], v19 offset:8192
  v_mov_b32 v168, 0
  v_mov_b32 v169, 0
  v_mfma_f32_16x16x32_bf16 v[108:111], v[232:235], v[44:47], 0
  v_mov_b32 v170, 0
  v_mov_b32 v171, 0
  v_mfma_f32_16x16x32_bf16 v[92:95], v[236:239], v[48:51], v[92:95]
  ds_read_b128 v[232:235], v16 offset:9216
  v_mov_b32 v172, 0
  v_mov_b32 v173, 0
  v_mfma_f32_16x16x32_bf16 v[108:111], v[236:239], v[52:55], v[108:111]
  s_waitcnt lgkmcnt(4)
  v_mov_b32 v174, 0
  v_mov_b32 v175, 0
  v_mfma_f32_16x16x32_bf16 v[92:95], v[240:243], v[56:59], v[92:95]
  ds_read_b128 v[236:239], v17 offset:9216
  v_mov_b32 v176, 0
  v_mov_b32 v177, 0
  v_mfma_f32_16x16x32_bf16 v[108:111], v[240:243], v[60:63], v[108:111]
  v_mov_b32 v178, 0
  v_mov_b32 v179, 0
  v_mfma_f32_16x16x32_bf16 v[92:95], v[244:247], v[64:67], v[92:95]
  ds_read_b128 v[240:243], v18 offset:9216
  v_mov_b32 v180, 0
  v_mov_b32 v181, 0
  v_mfma_f32_16x16x32_bf16 v[108:111], v[244:247], v[68:71], v[108:111]
  v_mov_b32 v182, 0
  v_mov_b32 v183, 0
  v_mfma_f32_16x16x32_bf16 v[96:99], v[216:219], v[40:43], 0
  ds_read_b128 v[244:247], v19 offset:9216
  v_mov_b32 v184, 0
  v_mov_b32 v185, 0
  v_mfma_f32_16x16x32_bf16 v[112:115], v[216:219], v[44:47], 0
  s_waitcnt lgkmcnt(4)
  v_mov_b32 v186, 0
  v_mov_b32 v187, 0
  v_mfma_f32_16x16x32_bf16 v[96:99], v[220:223], v[48:51], v[96:99]
  s_waitcnt vmcnt(16)
  s_barrier
  ds_read_b128 v[216:219], v16 offset:16384
  v_mov_b32 v188, 0
  v_mov_b32 v189, 0
  v_mfma_f32_16x16x32_bf16 v[112:115], v[220:223], v[52:55], v[112:115]
  v_mov_b32 v190, 0
  v_mov_b32 v191, 0
  v_mfma_f32_16x16x32_bf16 v[96:99], v[224:227], v[56:59], v[96:99]
  ds_read_b128 v[220:223], v17 offset:16384
  v_mov_b32 v192, 0
  v_mov_b32 v193, 0
  v_mfma_f32_16x16x32_bf16 v[112:115], v[224:227], v[60:63], v[112:115]
  v_mov_b32 v194, 0
  v_mov_b32 v195, 0
  v_mfma_f32_16x16x32_bf16 v[96:99], v[228:231], v[64:67], v[96:99]
  ds_read_b128 v[224:227], v18 offset:16384
  v_mov_b32 v196, 0
  v_mov_b32 v197, 0
  v_mfma_f32_16x16x32_bf16 v[112:115], v[228:231], v[68:71], v[112:115]
  s_waitcnt lgkmcnt(4)
  v_mov_b32 v198, 0
  v_mov_b32 v199, 0
  v_mfma_f32_16x16x32_bf16 v[100:103], v[232:235], v[40:43], 0
  ds_read_b128 v[228:231], v19 offset:16384
  v_mov_b32 v200, 0
  v_mov_b32 v201, 0
  v_mfma_f32_16x16x32_bf16 v[116:119], v[232:235], v[44:47], 0
  v_mov_b32 v202, 0
  v_mov_b32 v203, 0
  v_mfma_f32_16x16x32_bf16 v[100:103], v[236:239], v[48:51], v[100:103]
  ds_read_b128 v[232:235], v16 offset:17408
  v_mov_b32 v204, 0
  v_mov_b32 v205, 0
  v_mfma_f32_16x16x32_bf16 v[116:119], v[236:239], v[52:55], v[116:119]
  v_mov_b32 v206, 0
  v_mov_b32 v207, 0
  v_mfma_f32_16x16x32_bf16 v[100:103], v[240:243], v[56:59], v[100:103]
  ds_read_b128 v[236:239], v17 offset:17408
  v_mov_b32 v208, 0
  v_mov_b32 v209, 0
  v_mfma_f32_16x16x32_bf16 v[116:119], v[240:243], v[60:63], v[116:119]
  s_waitcnt lgkmcnt(6)
  v_mov_b32 v210, 0
  v_mov_b32 v211, 0
  v_mfma_f32_16x16x32_bf16 v[100:103], v[244:247], v[64:67], v[100:103]
  ds_read_b128 v[240:243], v18 offset:17408
  v_mov_b32 v212, 0
  v_mov_b32 v213, 0
  v_mfma_f32_16x16x32_bf16 v[116:119], v[244:247], v[68:71], v[116:119]
  v_mov_b32 v214, 0
  v_mov_b32 v215, 0
  s_barrier
  v_mov_b32 v80, 0
  v_mov_b32 v81, 0
  v_mov_b32 v82, 0
  v_mov_b32 v83, 0
  v_mov_b32 v84, 0
  v_mov_b32 v85, 0
  v_mov_b32 v86, 0
  v_mov_b32 v87, 0
  s_add_u32 m0, s30, 0
  s_cmp_lt_u32 s49, 0x80000
  s_cselect_b32 s18, 0x80000, 0
  buffer_load_dwordx4 v10, s[16:19], s49 offen offset:0 nt lds
  v_max3_f32 v32, v88, v89, v90
  v_max3_f32 v32, v32, v91, v92
  v_max3_f32 v32, v32, v93, v94
  v_max3_f32 v32, v32, v95, v96
  v_max3_f32 v32, v32, v97, v98
  v_max3_f32 v32, v32, v99, v100
  v_max3_f32 v32, v32, v101, v102
  v_max_f32 v32, v32, v103
  v_mov_b32 v30, v32
  s_nop 1
  v_permlane32_swap_b32 v32, v30
  s_nop 1
  v_max_f32 v32, v32, v30
  v_mov_b32 v30, v32
  s_nop 1
  v_permlane16_swap_b32 v32, v30
  s_nop 1
  v_max_f32 v32, v32, v30
  buffer_load_dwordx4 v10, s[16:19], s49 offen offset:1024 nt lds
  v_sub_f32 v72, 0, v32
  v_sub_f32 v73, 0, v32
  v_sub_f32 v74, 0, v32
  v_sub_f32 v75, 0, v32
  v_sub_f32 v88, v88, v32
  v_sub_f32 v89, v89, v32
  v_sub_f32 v90, v90, v32
  v_sub_f32 v91, v91, v32
  v_sub_f32 v92, v92, v32
  v_sub_f32 v93, v93, v32
  v_sub_f32 v94, v94, v32
  v_sub_f32 v95, v95, v32
  v_sub_f32 v96, v96, v32
  v_sub_f32 v97, v97, v32
  v_sub_f32 v98, v98, v32
  v_sub_f32 v99, v99, v32
  v_sub_f32 v100, v100, v32
  v_sub_f32 v101, v101, v32
  v_sub_f32 v102, v102, v32
  v_sub_f32 v103, v103, v32
  buffer_load_dwordx4 v11, s[16:19], s49 offen offset:2048 nt lds
  v_max3_f32 v33, v104, v105, v106
  v_max3_f32 v33, v33, v107, v108
  v_max3_f32 v33, v33, v109, v110
  v_max3_f32 v33, v33, v111, v112
  v_max3_f32 v33, v33, v113, v114
  v_max3_f32 v33, v33, v115, v116
  v_max3_f32 v33, v33, v117, v118
  v_max_f32 v33, v33, v119
  v_mov_b32 v30, v33
  s_nop 1
  v_permlane32_swap_b32 v33, v30
  s_nop 1
  v_max_f32 v33, v33, v30
  v_mov_b32 v30, v33
  s_nop 1
  v_permlane16_swap_b32 v33, v30
  s_nop 1
  v_max_f32 v33, v33, v30
  buffer_load_dwordx4 v11, s[16:19], s49 offen offset:3072 nt lds
  s_add_u32 s49, s49, 0x4000
  v_sub_f32 v76, 0, v33
  v_sub_f32 v77, 0, v33
  v_sub_f32 v78, 0, v33
  v_sub_f32 v79, 0, v33
  v_sub_f32 v104, v104, v33
  v_sub_f32 v105, v105, v33
  v_sub_f32 v106, v106, v33
  v_sub_f32 v107, v107, v33
  v_sub_f32 v108, v108, v33
  v_sub_f32 v109, v109, v33
  v_sub_f32 v110, v110, v33
  v_sub_f32 v111, v111, v33
  v_sub_f32 v112, v112, v33
  v_sub_f32 v113, v113, v33
  v_sub_f32 v114, v114, v33
  v_sub_f32 v115, v115, v33
  v_sub_f32 v116, v116, v33
  v_sub_f32 v117, v117, v33
  v_sub_f32 v118, v118, v33
  v_sub_f32 v119, v119, v33
  s_mov_b32 s33, 0
L_at:
  s_cmp_lg_u32 s33, 6
  s_cbranch_scc1 L_nocnt
  v_mov_b32 v39, 0
  buffer_load_dword v38, v39, s[64:67], 0 offen sc1
L_nocnt:
  s_waitcnt lgkmcnt(4)
  v_mfma_f32_16x16x32_bf16 v[120:123], v[216:219], v[40:43], v[72:75]
  ds_read_b128 v[244:247], v19 offset:17408
  v_exp_f32 v88, v88
  v_mfma_f32_16x16x32_bf16 v[136:139], v[216:219], v[44:47], v[76:79]
  v_exp_f32 v89, v89
  v_mfma_f32_16x16x32_bf16 v[120:123], v[220:223], v[48:51], v[120:123]
  ds_read_b128 v[216:219], v16 offset:24576
  v_exp_f32 v90, v90
  v_mfma_f32_16x16x32_bf16 v[136:139], v[220:223], v[52:55], v[136:139]
  v_exp_f32 v91, v91
  v_cvt_pk_bf16_f32 v88, v88, v89
  v_mfma_f32_16x16x32_bf16 v[120:123], v[224:227], v[56:59], v[120:123]
  ds_read_b128 v[220:223], v17 offset:24576
  v_cvt_pk_bf16_f32 v89, v90, v91
  v_mfma_f32_16x16x32_bf16 v[136:139], v[224:227], v[60:63], v[136:139]
  s_waitcnt lgkmcnt(4)
  v_exp_f32 v92, v92
  v_mfma_f32_16x16x32_bf16 v[120:123], v[228:231], v[64:67], v[120:123]
  ds_read_b128 v[224:227], v18 offset:24576
  v_exp_f32 v93, v93
  v_mfma_f32_16x16x32_bf16 v[136:139], v[228:231], v[68:71], v[136:139]
  v_exp_f32 v94, v94
  v_mfma_f32_16x16x32_bf16 v[124:127], v[232:235], v[40:43], v[72:75]
  ds_read_b128 v[228:231], v19 offset:24576
  v_exp_f32 v95, v95
  v_mfma_f32_16x16x32_bf16 v[140:143], v[232:235], v[44:47], v[76:79]
  v_cvt_pk_bf16_f32 v90, v92, v93
  v_cvt_pk_bf16_f32 v91, v94, v95
  v_mfma_f32_16x16x32_bf16 v[124:127], v[236:239], v[48:51], v[124:127]
  ds_read_b128 v[232:235], v16 offset:25600
  v_exp_f32 v104, v104
  v_mfma_f32_16x16x32_bf16 v[140:143], v[236:239], v[52:55], v[140:143]
  s_waitcnt lgkmcnt(4)
  v_exp_f32 v105, v105
  v_mfma_f32_16x16x32_bf16 v[124:127], v[240:243], v[56:59], v[124:127]
  ds_read_b128 v[236:239], v17 offset:25600
  v_exp_f32 v106, v106
  v_mfma_f32_16x16x32_bf16 v[140:143], v[240:243], v[60:63], v[140:143]
  v_exp_f32 v107, v107
  v_cvt_pk_bf16_f32 v104, v104, v105
  v_mfma_f32_16x16x32_bf16 v[124:127], v[244:247], v[64:67], v[124:127]
  ds_read_b128 v[240:243], v18 offset:25600
  v_cvt_pk_bf16_f32 v105, v106, v107
  v_mfma_f32_16x16x32_bf16 v[140:143], v[244:247], v[68:71], v[140:143]
  v_exp_f32 v108, v108
  v_mfma_f32_16x16x32_bf16 v[128:131], v[216:219], v[40:43], v[72:75]
  ds_read_b128 v[244:247], v19 offset:25600
  v_exp_f32 v109, v109
  v_mfma_f32_16x16x32_bf16 v[144:147], v[216:219], v[44:47], v[76:79]
  s_waitcnt lgkmcnt(4)
  v_exp_f32 v110, v110
  v_mfma_f32_16x16x32_bf16 v[128:131], v[220:223], v[48:51], v[128:131]
  ds_read_b64_tr_b16 v[216:217], v20 offset:49152
  v_exp_f32 v111, v111
  v_mfma_f32_16x16x32_bf16 v[144:147], v[220:223], v[52:55], v[144:147]
  ds_read_b64_tr_b16 v[218:219], v20 offset:50176
  v_cvt_pk_bf16_f32 v106, v108, v109
  v_cvt_pk_bf16_f32 v107, v110, v111
  v_mfma_f32_16x16x32_bf16 v[128:131], v[224:227], v[56:59], v[128:131]
  ds_read_b64_tr_b16 v[220:221], v21 offset:49152
  v_exp_f32 v96, v96
  v_mfma_f32_16x16x32_bf16 v[144:147], v[224:227], v[60:63], v[144:147]
  ds_read_b64_tr_b16 v[222:223], v21 offset:50176
  v_exp_f32 v97, v97
  v_mfma_f32_16x16x32_bf16 v[128:131], v[228:231], v[64:67], v[128:131]
  ds_read_b64_tr_b16 v[224:225], v22 offset:49152
  v_exp_f32 v98, v98
  v_mfma_f32_16x16x32_bf16 v[144:147], v[228:231], v[68:71], v[144:147]
  s_waitcnt lgkmcnt(6)
  ds_read_b64_tr_b16 v[226:227], v22 offset:50176
  v_mfma_f32_16x16x32_bf16 v[132:135], v[232:235], v[40:43], v[72:75]
  v_exp_f32 v99, v99
  v_cvt_pk_bf16_f32 v96, v96, v97
  v_mfma_f32_16x16x32_bf16 v[148:151], v[232:235], v[44:47], v[76:79]
  ds_read_b64_tr_b16 v[228:229], v23 offset:49152
  v_cvt_pk_bf16_f32 v97, v98, v99
  v_mfma_f32_16x16x32_bf16 v[132:135], v[236:239], v[48:51], v[132:135]
  s_and_b32 s80, s72, 7
  s_lshl_b32 s80, s80, 18
  ds_read_b64_tr_b16 v[230:231], v23 offset:50176
  v_mfma_f32_16x16x32_bf16 v[148:151], v[236:239], v[52:55], v[148:151]
  s_add_u32 s80, s80, s73
  s_lshl_b32 m0, s30, 1
  ds_read_b64_tr_b16 v[232:233], v24 offset:49152
  v_mfma_f32_16x16x32_bf16 v[132:135], v[240:243], v[56:59], v[132:135]
  s_add_u32 m0, m0, 65536
  s_lshr_b32 s72, s72, 4
  ds_read_b64_tr_b16 v[234:235], v24 offset:50176
  v_mfma_f32_16x16x32_bf16 v[148:151], v[240:243], v[60:63], v[148:151]
  s_waitcnt lgkmcnt(6)
  buffer_load_dwordx4 v14, s[56:59], s80 offen offset:0  lds
  ds_read_b64_tr_b16 v[236:237], v25 offset:49152
  v_mfma_f32_16x16x32_bf16 v[132:135], v[244:247], v[64:67], v[132:135]
  ds_read_b64_tr_b16 v[238:239], v25 offset:50176
  v_exp_f32 v100, v100
  v_mfma_f32_16x16x32_bf16 v[148:151], v[244:247], v[68:71], v[148:151]
  v_exp_f32 v101, v101
  v_mfma_f32_16x16x32_bf16 v[152:155], v[216:219], v[88:91], v[152:155]
  s_add_u32 s80, s80, 7168
  buffer_load_dwordx4 v14, s[56:59], s80 offen offset:1024  lds
  ds_read_b64_tr_b16 v[240:241], v26 offset:49152
  v_mfma_f32_16x16x32_bf16 v[156:159], v[216:219], v[104:107], v[156:159]
  ds_read_b64_tr_b16 v[242:243], v26 offset:50176
  v_exp_f32 v102, v102
  v_mfma_f32_16x16x32_bf16 v[160:163], v[220:223], v[88:91], v[160:163]
  ds_read_b64_tr_b16 v[244:245], v27 offset:49152
  v_exp_f32 v103, v103
  v_mfma_f32_16x16x32_bf16 v[164:167], v[220:223], v[104:107], v[164:167]
  s_waitcnt lgkmcnt(5)
  s_add_u32 s80, s80, 7168
  buffer_load_dwordx4 v14, s[56:59], s80 offen offset:2048  lds
  ds_read_b64_tr_b16 v[246:247], v27 offset:50176
  v_exp_f32 v112, v112
  v_cvt_pk_bf16_f32 v98, v100, v101
  v_cvt_pk_bf16_f32 v99, v102, v103
  v_mfma_f32_16x16x32_bf16 v[168:171], v[224:227], v[88:91], v[168:171]
  ds_read_b64_tr_b16 v[216:217], v20 offset:57344
  v_exp_f32 v113, v113
  v_mfma_f32_16x16x32_bf16 v[172:175], v[224:227], v[104:107], v[172:175]
  ds_read_b64_tr_b16 v[218:219], v20 offset:58368
  v_exp_f32 v114, v114
  v_mfma_f32_16x16x32_bf16 v[80:83], v[248:251], v[88:91], v[80:83]
  s_add_u32 s80, s80, 7168
  buffer_load_dwordx4 v14, s[56:59], s80 offen offset:3072  lds
  ds_read_b64_tr_b16 v[220:221], v21 offset:57344
  v_mfma_f32_16x16x32_bf16 v[176:179], v[228:231], v[88:91], v[176:179]
  ds_read_b64_tr_b16 v[222:223], v21 offset:58368
  v_exp_f32 v115, v115
  v_mfma_f32_16x16x32_bf16 v[180:183], v[228:231], v[104:107], v[180:183]
  ds_read_b64_tr_b16 v[224:225], v22 offset:57344
  v_cvt_pk_bf16_f32 v112, v112, v113
  v_cvt_pk_bf16_f32 v113, v114, v115
  v_mfma_f32_16x16x32_bf16 v[184:187], v[232:235], v[88:91], v[184:187]
  s_add_u32 m0, m0, 4096
  s_add_u32 s80, s80, 11264
  ds_read_b64_tr_b16 v[226:227], v22 offset:58368
  v_exp_f32 v116, v116
  v_mfma_f32_16x16x32_bf16 v[188:191], v[232:235], v[104:107], v[188:191]
  s_waitcnt lgkmcnt(6)
  buffer_load_dwordx4 v14, s[56:59], s80 offen offset:0  lds
  v_mfma_f32_16x16x32_bf16 v[192:195], v[236:239], v[88:91], v[192:195]
  ds_read_b64_tr_b16 v[228:229], v23 offset:57344
  v_exp_f32 v117, v117
  v_mfma_f32_16x16x32_bf16 v[196:199], v[236:239], v[104:107], v[196:199]
  ds_read_b64_tr_b16 v[230:231], v23 offset:58368
  v_exp_f32 v118, v118
  v_mfma_f32_16x16x32_bf16 v[84:87], v[248:251], v[104:107], v[84:87]
  s_add_u32 s80, s80, 7168
  buffer_load_dwordx4 v14, s[56:59], s80 offen offset:1024  lds
  ds_read_b64_tr_b16 v[232:233], v24 offset:57344
  v_mfma_f32_16x16x32_bf16 v[200:203], v[240:243], v[88:91], v[200:203]
  ds_read_b64_tr_b16 v[234:235], v24 offset:58368
  v_exp_f32 v119, v119
  v_mfma_f32_16x16x32_bf16 v[204:207], v[240:243], v[104:107], v[204:207]
  ds_read_b64_tr_b16 v[236:237], v25 offset:57344
  v_cvt_pk_bf16_f32 v114, v116, v117
  v_cvt_pk_bf16_f32 v115, v118, v119
  v_mfma_f32_16x16x32_bf16 v[208:211], v[244:247], v[88:91], v[208:211]
  s_add_u32 s80, s80, 7168
  buffer_load_dwordx4 v14, s[56:59], s80 offen offset:2048  lds
  ds_read_b64_tr_b16 v[238:239], v25 offset:58368
  v_mfma_f32_16x16x32_bf16 v[212:215], v[244:247], v[104:107], v[212:215]
  s_waitcnt lgkmcnt(6)
  v_max3_f32 v29, v120, v121, v122
  v_mfma_f32_16x16x32_bf16 v[152:155], v[216:219], v[96:99], v[152:155]
  ds_read_b64_tr_b16 v[240:241], v26 offset:57344
  v_max3_f32 v29, v29, v123, v136
  v_mfma_f32_16x16x32_bf16 v[156:159], v[216:219], v[112:115], v[156:159]
  s_add_u32 s80, s80, 7168
  buffer_load_dwordx4 v14, s[56:59], s80 offen offset:3072  lds
  ds_read_b64_tr_b16 v[242:243], v26 offset:58368
  v_mfma_f32_16x16x32_bf16 v[160:163], v[220:223], v[96:99], v[160:163]
  ds_read_b64_tr_b16 v[244:245], v27 offset:57344
  v_max3_f32 v29, v29, v137, v138
  v_max3_f32 v29, v29, v139, v124
  v_mfma_f32_16x16x32_bf16 v[164:167], v[220:223], v[112:115], v[164:167]
  ds_read_b64_tr_b16 v[246:247], v27 offset:58368
  v_max3_f32 v29, v29, v125, v126
  v_max3_f32 v29, v29, v127, v140
  v_mfma_f32_16x16x32_bf16 v[168:171], v[224:227], v[96:99], v[168:171]
  s_waitcnt vmcnt(20)
  s_barrier
  ds_read_b128 v[216:219], v16 offset:32768
  v_mfma_f32_16x16x32_bf16 v[172:175], v[224:227], v[112:115], v[172:175]
  v_max3_f32 v29, v29, v141, v142
  v_max3_f32 v29, v29, v143, v128
  v_max3_f32 v29, v29, v129, v130
  v_mfma_f32_16x16x32_bf16 v[80:83], v[248:251], v[96:99], v[80:83]
  s_waitcnt lgkmcnt(5)
  s_add_u32 m0, s30, 131072
  s_cmp_lt_u32 s50, 0x80000
  ds_read_b128 v[220:223], v17 offset:32768
  v_mfma_f32_16x16x32_bf16 v[176:179], v[228:231], v[96:99], v[176:179]
  s_cselect_b32 s22, 0x80000, 0
  buffer_load_dwordx4 v12, s[20:23], s50 offen offset:0 nt lds
  v_mfma_f32_16x16x32_bf16 v[180:183], v[228:231], v[112:115], v[180:183]
  buffer_load_dwordx4 v12, s[20:23], s50 offen offset:1024 nt lds
  ds_read_b128 v[224:227], v18 offset:32768
  v_mfma_f32_16x16x32_bf16 v[184:187], v[232:235], v[96:99], v[184:187]
  buffer_load_dwordx4 v13, s[20:23], s50 offen offset:2048 nt lds
  v_max3_f32 v29, v29, v131, v144
  v_max3_f32 v29, v29, v145, v146
  v_mfma_f32_16x16x32_bf16 v[188:191], v[232:235], v[112:115], v[188:191]
  buffer_load_dwordx4 v13, s[20:23], s50 offen offset:3072 nt lds
  ds_read_b128 v[228:231], v19 offset:32768
  v_max3_f32 v29, v29, v147, v132
  v_mfma_f32_16x16x32_bf16 v[192:195], v[236:239], v[96:99], v[192:195]
  s_add_u32 s50, s50, 0x4000
  s_add_u32 m0, s30, 16384
  v_max3_f32 v29, v29, v133, v134
  v_mfma_f32_16x16x32_bf16 v[196:199], v[236:239], v[112:115], v[196:199]
  s_cmp_lt_u32 s49, 0x80000
  s_cselect_b32 s18, 0x80000, 0
  ds_read_b128 v[232:235], v16 offset:33792
  v_mfma_f32_16x16x32_bf16 v[84:87], v[248:251], v[112:115], v[84:87]
  s_waitcnt lgkmcnt(5)
  buffer_load_dwordx4 v10, s[16:19], s49 offen offset:0 nt lds
  v_max3_f32 v29, v29, v135, v148
  v_mfma_f32_16x16x32_bf16 v[200:203], v[240:243], v[96:99], v[200:203]
  buffer_load_dwordx4 v10, s[16:19], s49 offen offset:1024 nt lds
  ds_read_b128 v[236:239], v17 offset:33792
  v_max3_f32 v29, v29, v149, v150
  v_mfma_f32_16x16x32_bf16 v[204:207], v[240:243], v[112:115], v[204:207]
  buffer_load_dwordx4 v11, s[16:19], s49 offen offset:2048 nt lds
  v_max_f32 v29, v29, v151
  v_cmp_lt_f32 vcc, s51, v29
  v_mfma_f32_16x16x32_bf16 v[208:211], v[244:247], v[96:99], v[208:211]
  buffer_load_dwordx4 v11, s[16:19], s49 offen offset:3072 nt lds
  s_add_u32 s49, s49, 0x4000
  ds_read_b128 v[240:243], v18 offset:33792
  v_mfma_f32_16x16x32_bf16 v[212:215], v[244:247], v[112:115], v[212:215]
  s_cbranch_vccnz L_rare0
L_rare0_ret:
  s_mov_b32 s5, 0x30000
  s_bitcmp1_b32 s28, s33
  s_cselect_b32 s77, 0, 0x80000
  s_cselect_b32 s3, s5, 147456
  s_cselect_b32 s4, s5, 32768
  s_add_u32 s82, s30, s3
  s_add_u32 s96, s30, s4
  s_waitcnt lgkmcnt(4)
  v_mfma_f32_16x16x32_bf16 v[88:91], v[216:219], v[40:43], v[72:75]
  ds_read_b128 v[244:247], v19 offset:33792
  v_exp_f32 v120, v120
  v_mfma_f32_16x16x32_bf16 v[104:107], v[216:219], v[44:47], v[76:79]
  v_exp_f32 v121, v121
  v_mfma_f32_16x16x32_bf16 v[88:91], v[220:223], v[48:51], v[88:91]
  ds_read_b128 v[216:219], v16 offset:40960
  v_exp_f32 v122, v122
  v_mfma_f32_16x16x32_bf16 v[104:107], v[220:223], v[52:55], v[104:107]
  v_exp_f32 v123, v123
  v_cvt_pk_bf16_f32 v120, v120, v121
  v_mfma_f32_16x16x32_bf16 v[88:91], v[224:227], v[56:59], v[88:91]
  ds_read_b128 v[220:223], v17 offset:40960
  v_cvt_pk_bf16_f32 v121, v122, v123
  v_mfma_f32_16x16x32_bf16 v[104:107], v[224:227], v[60:63], v[104:107]
  s_waitcnt lgkmcnt(4)
  v_exp_f32 v124, v124
  v_mfma_f32_16x16x32_bf16 v[88:91], v[228:231], v[64:67], v[88:91]
  ds_read_b128 v[224:227], v18 offset:40960
  v_exp_f32 v125, v125
  v_mfma_f32_16x16x32_bf16 v[104:107], v[228:231], v[68:71], v[104:107]
  v_exp_f32 v126, v126
  v_mfma_f32_16x16x32_bf16 v[92:95], v[232:235], v[40:43], v[72:75]
  ds_read_b128 v[228:231], v19 offset:40960
  v_exp_f32 v127, v127
  v_mfma_f32_16x16x32_bf16 v[108:111], v[232:235], v[44:47], v[76:79]
  v_cvt_pk_bf16_f32 v122, v124, v125
  v_cvt_pk_bf16_f32 v123, v126, v127
  v_mfma_f32_16x16x32_bf16 v[92:95], v[236:239], v[48:51], v[92:95]
  ds_read_b128 v[232:235], v16 offset:41984
  v_exp_f32 v136, v136
  v_mfma_f32_16x16x32_bf16 v[108:111], v[236:239], v[52:55], v[108:111]
  s_waitcnt lgkmcnt(4)
  v_mfma_f32_16x16x32_bf16 v[92:95], v[240:243], v[56:59], v[92:95]
  ds_read_b128 v[236:239], v17 offset:41984
  v_exp_f32 v137, v137
  v_mfma_f32_16x16x32_bf16 v[108:111], v[240:243], v[60:63], v[108:111]
  v_exp_f32 v138, v138
  v_mfma_f32_16x16x32_bf16 v[92:95], v[244:247], v[64:67], v[92:95]
  ds_read_b128 v[240:243], v18 offset:41984
  v_exp_f32 v139, v139
  v_mfma_f32_16x16x32_bf16 v[108:111], v[244:247], v[68:71], v[108:111]
  v_cvt_pk_bf16_f32 v136, v136, v137
  v_cvt_pk_bf16_f32 v137, v138, v139
  v_mfma_f32_16x16x32_bf16 v[96:99], v[216:219], v[40:43], v[72:75]
  ds_read_b128 v[244:247], v19 offset:41984
  v_exp_f32 v140, v140
  v_mfma_f32_16x16x32_bf16 v[112:115], v[216:219], v[44:47], v[76:79]
  s_waitcnt lgkmcnt(4)
  v_exp_f32 v141, v141
  v_mfma_f32_16x16x32_bf16 v[96:99], v[220:223], v[48:51], v[96:99]
  ds_read_b64_tr_b16 v[216:217], v20 offset:0
  v_exp_f32 v142, v142
  v_mfma_f32_16x16x32_bf16 v[112:115], v[220:223], v[52:55], v[112:115]
  ds_read_b64_tr_b16 v[218:219], v20 offset:1024
  v_exp_f32 v143, v143
  v_mfma_f32_16x16x32_bf16 v[96:99], v[224:227], v[56:59], v[96:99]
  ds_read_b64_tr_b16 v[220:221], v21 offset:0
  v_cvt_pk_bf16_f32 v138, v140, v141
  v_cvt_pk_bf16_f32 v139, v142, v143
  v_mfma_f32_16x16x32_bf16 v[112:115], v[224:227], v[60:63], v[112:115]
  ds_read_b64_tr_b16 v[222:223], v21 offset:1024
  v_mfma_f32_16x16x32_bf16 v[96:99], v[228:231], v[64:67], v[96:99]
  ds_read_b64_tr_b16 v[224:225], v22 offset:0
  v_exp_f32 v128, v128
  v_mfma_f32_16x16x32_bf16 v[112:115], v[228:231], v[68:71], v[112:115]
  s_waitcnt lgkmcnt(6)
  ds_read_b64_tr_b16 v[226:227], v22 offset:1024
  v_mfma_f32_16x16x32_bf16 v[100:103], v[232:235], v[40:43], v[72:75]
  v_exp_f32 v129, v129
  v_mfma_f32_16x16x32_bf16 v[116:119], v[232:235], v[44:47], v[76:79]
  ds_read_b64_tr_b16 v[228:229], v23 offset:0
  v_exp_f32 v130, v130
  v_mfma_f32_16x16x32_bf16 v[100:103], v[236:239], v[48:51], v[100:103]
  ds_read_b64_tr_b16 v[230:231], v23 offset:1024
  v_exp_f32 v131, v131
  v_mfma_f32_16x16x32_bf16 v[116:119], v[236:239], v[52:55], v[116:119]
  ds_read_b64_tr_b16 v[232:233], v24 offset:0
  v_cvt_pk_bf16_f32 v128, v128, v129
  v_cvt_pk_bf16_f32 v129, v130, v131
  v_mfma_f32_16x16x32_bf16 v[100:103], v[240:243], v[56:59], v[100:103]
  ds_read_b64_tr_b16 v[234:235], v24 offset:1024
  v_exp_f32 v132, v132
  v_mfma_f32_16x16x32_bf16 v[116:119], v[240:243], v[60:63], v[116:119]
  s_waitcnt lgkmcnt(6)
  ds_read_b64_tr_b16 v[236:237], v25 offset:0
  v_mfma_f32_16x16x32_bf16 v[100:103], v[244:247], v[64:67], v[100:103]
  ds_read_b64_tr_b16 v[238:239], v25 offset:1024
  v_exp_f32 v133, v133
  v_mfma_f32_16x16x32_bf16 v[116:119], v[244:247], v[68:71], v[116:119]
  v_exp_f32 v134, v134
  v_mfma_f32_16x16x32_bf16 v[152:155], v[216:219], v[120:123], v[152:155]
  ds_read_b64_tr_b16 v[240:241], v26 offset:0
  v_exp_f32 v135, v135
  v_mfma_f32_16x16x32_bf16 v[156:159], v[216:219], v[136:139], v[156:159]
  ds_read_b64_tr_b16 v[242:243], v26 offset:1024
  v_cvt_pk_bf16_f32 v130, v132, v133
  v_cvt_pk_bf16_f32 v131, v134, v135
  v_mfma_f32_16x16x32_bf16 v[160:163], v[220:223], v[120:123], v[160:163]
  ds_read_b64_tr_b16 v[244:245], v27 offset:0
  v_exp_f32 v144, v144
  v_mfma_f32_16x16x32_bf16 v[164:167], v[220:223], v[136:139], v[164:167]
  s_waitcnt lgkmcnt(5)
  ds_read_b64_tr_b16 v[246:247], v27 offset:1024
  v_mfma_f32_16x16x32_bf16 v[168:171], v[224:227], v[120:123], v[168:171]
  ds_read_b64_tr_b16 v[216:217], v20 offset:8192
  v_exp_f32 v145, v145
  v_mfma_f32_16x16x32_bf16 v[172:175], v[224:227], v[136:139], v[172:175]
  ds_read_b64_tr_b16 v[218:219], v20 offset:9216
  v_mfma_f32_16x16x32_bf16 v[80:83], v[248:251], v[120:123], v[80:83]
  ds_read_b64_tr_b16 v[220:221], v21 offset:8192
  v_exp_f32 v146, v146
  v_mfma_f32_16x16x32_bf16 v[176:179], v[228:231], v[120:123], v[176:179]
  ds_read_b64_tr_b16 v[222:223], v21 offset:9216
  v_exp_f32 v147, v147
  v_mfma_f32_16x16x32_bf16 v[180:183], v[228:231], v[136:139], v[180:183]
  ds_read_b64_tr_b16 v[224:225], v22 offset:8192
  v_cvt_pk_bf16_f32 v144, v144, v145
  v_cvt_pk_bf16_f32 v145, v146, v147
  v_mfma_f32_16x16x32_bf16 v[184:187], v[232:235], v[120:123], v[184:187]
  ds_read_b64_tr_b16 v[226:227], v22 offset:9216
  v_exp_f32 v148, v148
  v_mfma_f32_16x16x32_bf16 v[188:191], v[232:235], v[136:139], v[188:191]
  s_waitcnt lgkmcnt(6)
  v_mfma_f32_16x16x32_bf16 v[192:195], v[236:239], v[120:123], v[192:195]
  ds_read_b64_tr_b16 v[228:229], v23 offset:8192
  v_exp_f32 v149, v149
  v_mfma_f32_16x16x32_bf16 v[196:199], v[236:239], v[136:139], v[196:199]
  ds_read_b64_tr_b16 v[230:231], v23 offset:9216
  v_exp_f32 v150, v150
  v_mfma_f32_16x16x32_bf16 v[84:87], v[248:251], v[136:139], v[84:87]
  ds_read_b64_tr_b16 v[232:233], v24 offset:8192
  v_exp_f32 v151, v151
  v_mfma_f32_16x16x32_bf16 v[200:203], v[240:243], v[120:123], v[200:203]
  ds_read_b64_tr_b16 v[234:235], v24 offset:9216
  v_cvt_pk_bf16_f32 v146, v148, v149
  v_mfma_f32_16x16x32_bf16 v[204:207], v[240:243], v[136:139], v[204:207]
  ds_read_b64_tr_b16 v[236:237], v25 offset:8192
  v_cvt_pk_bf16_f32 v147, v150, v151
  v_max3_f32 v29, v88, v89, v90
  v_mfma_f32_16x16x32_bf16 v[208:211], v[244:247], v[120:123], v[208:211]
  ds_read_b64_tr_b16 v[238:239], v25 offset:9216
  v_max3_f32 v29, v29, v91, v104
  v_max3_f32 v29, v29, v105, v106
  v_mfma_f32_16x16x32_bf16 v[212:215], v[244:247], v[136:139], v[212:215]
  s_waitcnt lgkmcnt(6)
  v_max3_f32 v29, v29, v107, v92
  v_mfma_f32_16x16x32_bf16 v[152:155], v[216:219], v[128:131], v[152:155]
  ds_read_b64_tr_b16 v[240:241], v26 offset:8192
  v_max3_f32 v29, v29, v93, v94
  v_max3_f32 v29, v29, v95, v108
  v_mfma_f32_16x16x32_bf16 v[156:159], v[216:219], v[144:147], v[156:159]
  ds_read_b64_tr_b16 v[242:243], v26 offset:9216
  v_max3_f32 v29, v29, v109, v110
  v_mfma_f32_16x16x32_bf16 v[160:163], v[220:223], v[128:131], v[160:163]
  ds_read_b64_tr_b16 v[244:245], v27 offset:8192
  v_max3_f32 v29, v29, v111, v96
  v_max3_f32 v29, v29, v97, v98
  v_mfma_f32_16x16x32_bf16 v[164:167], v[220:223], v[144:147], v[164:167]
  ds_read_b64_tr_b16 v[246:247], v27 offset:9216
  v_max3_f32 v29, v29, v99, v112
  v_mfma_f32_16x16x32_bf16 v[168:171], v[224:227], v[128:131], v[168:171]
  s_waitcnt vmcnt(20)
  s_barrier
  ds_read_b128 v[216:219], v16 offset:49152
  v_mfma_f32_16x16x32_bf16 v[172:175], v[224:227], v[144:147], v[172:175]
  v_max3_f32 v29, v29, v113, v114
  v_max3_f32 v29, v29, v115, v100
  v_max3_f32 v29, v29, v101, v102
  v_mfma_f32_16x16x32_bf16 v[80:83], v[248:251], v[128:131], v[80:83]
  s_waitcnt lgkmcnt(5)
  s_mov_b32 m0, s82
  s_cmp_lt_u32 s50, s77
  ds_read_b128 v[220:223], v17 offset:49152
  v_mfma_f32_16x16x32_bf16 v[176:179], v[228:231], v[128:131], v[176:179]
  s_cselect_b32 s22, 0x80000, 0
  buffer_load_dwordx4 v12, s[20:23], s50 offen offset:0 nt lds
  v_mfma_f32_16x16x32_bf16 v[180:183], v[228:231], v[144:147], v[180:183]
  buffer_load_dwordx4 v12, s[20:23], s50 offen offset:1024 nt lds
  ds_read_b128 v[224:227], v18 offset:49152
  v_mfma_f32_16x16x32_bf16 v[184:187], v[232:235], v[128:131], v[184:187]
  buffer_load_dwordx4 v13, s[20:23], s50 offen offset:2048 nt lds
  v_max3_f32 v29, v29, v103, v116
  v_mfma_f32_16x16x32_bf16 v[188:191], v[232:235], v[144:147], v[188:191]
  buffer_load_dwordx4 v13, s[20:23], s50 offen offset:3072 nt lds
  ds_read_b128 v[228:231], v19 offset:49152
  v_mfma_f32_16x16x32_bf16 v[192:195], v[236:239], v[128:131], v[192:195]
  s_add_u32 s50, s50, 0x4000
  s_mov_b32 m0, s96
  v_max3_f32 v29, v29, v117, v118
  v_mfma_f32_16x16x32_bf16 v[196:199], v[236:239], v[144:147], v[196:199]
  s_cmp_lt_u32 s49, s77
  s_cselect_b32 s18, 0x80000, 0
  ds_read_b128 v[232:235], v16 offset:50176
  v_mfma_f32_16x16x32_bf16 v[84:87], v[248:251], v[144:147], v[84:87]
  s_waitcnt lgkmcnt(5)
  buffer_load_dwordx4 v10, s[16:19], s49 offen offset:0 nt lds
  v_mfma_f32_16x16x32_bf16 v[200:203], v[240:243], v[128:131], v[200:203]
  buffer_load_dwordx4 v10, s[16:19], s49 offen offset:1024 nt lds
  ds_read_b128 v[236:239], v17 offset:50176
  v_max_f32 v29, v29, v119
  v_mfma_f32_16x16x32_bf16 v[204:207], v[240:243], v[144:147], v[204:207]
  buffer_load_dwordx4 v11, s[16:19], s49 offen offset:2048 nt lds
  v_cmp_lt_f32 vcc, s51, v29
  v_mfma_f32_16x16x32_bf16 v[208:211], v[244:247], v[128:131], v[208:211]
  buffer_load_dwordx4 v11, s[16:19], s49 offen offset:3072 nt lds
  s_add_u32 s49, s49, 0x4000
  ds_read_b128 v[240:243], v18 offset:50176
  v_mfma_f32_16x16x32_bf16 v[212:215], v[244:247], v[144:147], v[212:215]
  s_cbranch_vccnz L_rare1
L_rare1_ret:
  s_cmp_lg_u32 s77, 0
  s_cbranch_scc1 L_sgdone
  s_cmp_lg_u32 s33, 4
  s_cbranch_scc1 L_sg1
  ds_write_b128 v31, a[128:131] offset:49152
  ds_write_b128 v31, a[132:135] offset:50176
  ds_write_b128 v31, a[136:139] offset:51200
  ds_write_b128 v31, a[140:143] offset:52224
  v_add_u32 v30, -65536, v31
  ds_write_b128 v30, a[144:147] offset:0
  ds_write_b128 v30, a[148:151] offset:1024
  ds_write_b128 v30, a[152:155] offset:2048
  ds_write_b128 v30, a[156:159] offset:3072
  s_waitcnt lgkmcnt(0)
  s_branch L_sgdone
L_sg1:
  s_cmp_lg_u32 s33, 2
  s_cbranch_scc1 L_sg2
  ds_write_b128 v31, a[64:67] offset:49152
  ds_write_b128 v31, a[68:71] offset:50176
  ds_write_b128 v31, a[72:75] offset:51200
  ds_write_b128 v31, a[76:79] offset:52224
  v_add_u32 v30, -65536, v31
  ds_write_b128 v30, a[80:83] offset:0
  ds_write_b128 v30, a[84:87] offset:1024
  ds_write_b128 v30, a[88:91] offset:2048
  ds_write_b128 v30, a[92:95] offset:3072
  s_waitcnt lgkmcnt(0)
  s_branch L_sgdone
L_sg2:
  ds_write_b128 v31, a[160:163] offset:49152
  ds_write_b128 v31, a[164:167] offset:50176
  ds_write_b128 v31, a[168:171] offset:51200
  ds_write_b128 v31, a[172:175] offset:52224
  v_add_u32 v30, -65536, v31
  ds_write_b128 v30, a[176:179] offset:0
  ds_write_b128 v30, a[180:183] offset:1024
  ds_write_b128 v30, a[184:187] offset:2048
  ds_write_b128 v30, a[188:191] offset:3072
  s_waitcnt lgkmcnt(0)
L_sgdone:
  s_cmp_eq_u32 s33, 7
  s_cbranch_scc1 L_at_last
  s_waitcnt lgkmcnt(4)
  v_mfma_f32_16x16x32_bf16 v[120:123], v[216:219], v[40:43], v[72:75]
  ds_read_b128 v[244:247], v19 offset:50176
  v_exp_f32 v88, v88
  v_mfma_f32_16x16x32_bf16 v[136:139], v[216:219], v[44:47], v[76:79]
  v_exp_f32 v89, v89
  v_mfma_f32_16x16x32_bf16 v[120:123], v[220:223], v[48:51], v[120:123]
  ds_read_b128 v[216:219], v16 offset:57344
  v_exp_f32 v90, v90
  v_mfma_f32_16x16x32_bf16 v[136:139], v[220:223], v[52:55], v[136:139]
  v_exp_f32 v91, v91
  v_cvt_pk_bf16_f32 v88, v88, v89
  v_mfma_f32_16x16x32_bf16 v[120:123], v[224:227], v[56:59], v[120:123]
  ds_read_b128 v[220:223], v17 offset:57344
  v_cvt_pk_bf16_f32 v89, v90, v91
  v_mfma_f32_16x16x32_bf16 v[136:139], v[224:227], v[60:63], v[136:139]
  s_waitcnt lgkmcnt(4)
  v_exp_f32 v92, v92
  v_mfma_f32_16x16x32_bf16 v[120:123], v[228:231], v[64:67], v[120:123]
  ds_read_b128 v[224:227], v18 offset:57344
  v_exp_f32 v93, v93
  v_mfma_f32_16x16x32_bf16 v[136:139], v[228:231], v[68:71], v[136:139]
  v_exp_f32 v94, v94
  v_mfma_f32_16x16x32_bf16 v[124:127], v[232:235], v[40:43], v[72:75]
  ds_read_b128 v[228:231], v19 offset:57344
  v_exp_f32 v95, v95
  v_mfma_f32_16x16x32_bf16 v[140:143], v[232:235], v[44:47], v[76:79]
  v_cvt_pk_bf16_f32 v90, v92, v93
  v_cvt_pk_bf16_f32 v91, v94, v95
  v_mfma_f32_16x16x32_bf16 v[124:127], v[236:239], v[48:51], v[124:127]
  ds_read_b128 v[232:235], v16 offset:58368
  v_exp_f32 v104, v104
  v_mfma_f32_16x16x32_bf16 v[140:143], v[236:239], v[52:55], v[140:143]
  s_waitcnt lgkmcnt(4)
  v_mfma_f32_16x16x32_bf16 v[124:127], v[240:243], v[56:59], v[124:127]
  ds_read_b128 v[236:239], v17 offset:58368
  v_exp_f32 v105, v105
  v_mfma_f32_16x16x32_bf16 v[140:143], v[240:243], v[60:63], v[140:143]
  v_exp_f32 v106, v106
  v_mfma_f32_16x16x32_bf16 v[124:127], v[244:247], v[64:67], v[124:127]
  ds_read_b128 v[240:243], v18 offset:58368
  v_exp_f32 v107, v107
  v_mfma_f32_16x16x32_bf16 v[140:143], v[244:247], v[68:71], v[140:143]
  v_cvt_pk_bf16_f32 v104, v104, v105
  v_cvt_pk_bf16_f32 v105, v106, v107
  v_mfma_f32_16x16x32_bf16 v[128:131], v[216:219], v[40:43], v[72:75]
  ds_read_b128 v[244:247], v19 offset:58368
  v_exp_f32 v108, v108
  v_mfma_f32_16x16x32_bf16 v[144:147], v[216:219], v[44:47], v[76:79]
  s_waitcnt lgkmcnt(4)
  v_exp_f32 v109, v109
  v_mfma_f32_16x16x32_bf16 v[128:131], v[220:223], v[48:51], v[128:131]
  ds_read_b64_tr_b16 v[216:217], v20 offset:16384
  v_exp_f32 v110, v110
  v_mfma_f32_16x16x32_bf16 v[144:147], v[220:223], v[52:55], v[144:147]
  ds_read_b64_tr_b16 v[218:219], v20 offset:17408
  v_exp_f32 v111, v111
  v_mfma_f32_16x16x32_bf16 v[128:131], v[224:227], v[56:59], v[128:131]
  ds_read_b64_tr_b16 v[220:221], v21 offset:16384
  v_cvt_pk_bf16_f32 v106, v108, v109
  v_cvt_pk_bf16_f32 v107, v110, v111
  v_mfma_f32_16x16x32_bf16 v[144:147], v[224:227], v[60:63], v[144:147]
  ds_read_b64_tr_b16 v[222:223], v21 offset:17408
  v_mfma_f32_16x16x32_bf16 v[128:131], v[228:231], v[64:67], v[128:131]
  ds_read_b64_tr_b16 v[224:225], v22 offset:16384
  v_exp_f32 v96, v96
  v_mfma_f32_16x16x32_bf16 v[144:147], v[228:231], v[68:71], v[144:147]
  s_waitcnt lgkmcnt(6)
  ds_read_b64_tr_b16 v[226:227], v22 offset:17408
  v_mfma_f32_16x16x32_bf16 v[132:135], v[232:235], v[40:43], v[72:75]
  v_exp_f32 v97, v97
  v_mfma_f32_16x16x32_bf16 v[148:151], v[232:235], v[44:47], v[76:79]
  ds_read_b64_tr_b16 v[228:229], v23 offset:16384
  v_exp_f32 v98, v98
  v_mfma_f32_16x16x32_bf16 v[132:135], v[236:239], v[48:51], v[132:135]
  ds_read_b64_tr_b16 v[230:231], v23 offset:17408
  v_exp_f32 v99, v99
  v_mfma_f32_16x16x32_bf16 v[148:151], v[236:239], v[52:55], v[148:151]
  ds_read_b64_tr_b16 v[232:233], v24 offset:16384
  v_cvt_pk_bf16_f32 v96, v96, v97
  v_cvt_pk_bf16_f32 v97, v98, v99
  v_mfma_f32_16x16x32_bf16 v[132:135], v[240:243], v[56:59], v[132:135]
  ds_read_b64_tr_b16 v[234:235], v24 offset:17408
  v_exp_f32 v100, v100
  v_mfma_f32_16x16x32_bf16 v[148:151], v[240:243], v[60:63], v[148:151]
  s_waitcnt lgkmcnt(6)
  ds_read_b64_tr_b16 v[236:237], v25 offset:16384
  v_mfma_f32_16x16x32_bf16 v[132:135], v[244:247], v[64:67], v[132:135]
  ds_read_b64_tr_b16 v[238:239], v25 offset:17408
  v_exp_f32 v101, v101
  v_mfma_f32_16x16x32_bf16 v[148:151], v[244:247], v[68:71], v[148:151]
  v_exp_f32 v102, v102
  v_mfma_f32_16x16x32_bf16 v[152:155], v[216:219], v[88:91], v[152:155]
  ds_read_b64_tr_b16 v[240:241], v26 offset:16384
  v_exp_f32 v103, v103
  v_mfma_f32_16x16x32_bf16 v[156:159], v[216:219], v[104:107], v[156:159]
  ds_read_b64_tr_b16 v[242:243], v26 offset:17408
  v_cvt_pk_bf16_f32 v98, v100, v101
  v_cvt_pk_bf16_f32 v99, v102, v103
  v_mfma_f32_16x16x32_bf16 v[160:163], v[220:223], v[88:91], v[160:163]
  ds_read_b64_tr_b16 v[244:245], v27 offset:16384
  v_exp_f32 v112, v112
  v_mfma_f32_16x16x32_bf16 v[164:167], v[220:223], v[104:107], v[164:167]
  s_waitcnt lgkmcnt(5)
  ds_read_b64_tr_b16 v[246:247], v27 offset:17408
  v_mfma_f32_16x16x32_bf16 v[168:171], v[224:227], v[88:91], v[168:171]
  ds_read_b64_tr_b16 v[216:217], v20 offset:24576
  v_exp_f32 v113, v113
  v_mfma_f32_16x16x32_bf16 v[172:175], v[224:227], v[104:107], v[172:175]
  ds_read_b64_tr_b16 v[218:219], v20 offset:25600
  v_mfma_f32_16x16x32_bf16 v[80:83], v[248:251], v[88:91], v[80:83]
  ds_read_b64_tr_b16 v[220:221], v21 offset:24576
  v_exp_f32 v114, v114
  v_mfma_f32_16x16x32_bf16 v[176:179], v[228:231], v[88:91], v[176:179]
  ds_read_b64_tr_b16 v[222:223], v21 offset:25600
  v_exp_f32 v115, v115
  v_mfma_f32_16x16x32_bf16 v[180:183], v[228:231], v[104:107], v[180:183]
  ds_read_b64_tr_b16 v[224:225], v22 offset:24576
  v_cvt_pk_bf16_f32 v112, v112, v113
  v_cvt_pk_bf16_f32 v113, v114, v115
  v_mfma_f32_16x16x32_bf16 v[184:187], v[232:235], v[88:91], v[184:187]
  ds_read_b64_tr_b16 v[226:227], v22 offset:25600
  v_exp_f32 v116, v116
  v_mfma_f32_16x16x32_bf16 v[188:191], v[232:235], v[104:107], v[188:191]
  s_waitcnt lgkmcnt(6)
  v_mfma_f32_16x16x32_bf16 v[192:195], v[236:239], v[88:91], v[192:195]
  ds_read_b64_tr_b16 v[228:229], v23 offset:24576
  v_exp_f32 v117, v117
  v_mfma_f32_16x16x32_bf16 v[196:199], v[236:239], v[104:107], v[196:199]
  ds_read_b64_tr_b16 v[230:231], v23 offset:25600
  v_exp_f32 v118, v118
  v_mfma_f32_16x16x32_bf16 v[84:87], v[248:251], v[104:107], v[84:87]
  ds_read_b64_tr_b16 v[232:233], v24 offset:24576
  v_exp_f32 v119, v119
  v_mfma_f32_16x16x32_bf16 v[200:203], v[240:243], v[88:91], v[200:203]
  ds_read_b64_tr_b16 v[234:235], v24 offset:25600
  v_cvt_pk_bf16_f32 v114, v116, v117
  v_mfma_f32_16x16x32_bf16 v[204:207], v[240:243], v[104:107], v[204:207]
  ds_read_b64_tr_b16 v[236:237], v25 offset:24576
  v_cvt_pk_bf16_f32 v115, v118, v119
  v_max3_f32 v29, v120, v121, v122
  v_mfma_f32_16x16x32_bf16 v[208:211], v[244:247], v[88:91], v[208:211]
  ds_read_b64_tr_b16 v[238:239], v25 offset:25600
  v_max3_f32 v29, v29, v123, v136
  v_max3_f32 v29, v29, v137, v138
  v_mfma_f32_16x16x32_bf16 v[212:215], v[244:247], v[104:107], v[212:215]
  s_waitcnt lgkmcnt(6)
  v_max3_f32 v29, v29, v139, v124
  v_mfma_f32_16x16x32_bf16 v[152:155], v[216:219], v[96:99], v[152:155]
  ds_read_b64_tr_b16 v[240:241], v26 offset:24576
  v_max3_f32 v29, v29, v125, v126
  v_max3_f32 v29, v29, v127, v140
  v_mfma_f32_16x16x32_bf16 v[156:159], v[216:219], v[112:115], v[156:159]
  ds_read_b64_tr_b16 v[242:243], v26 offset:25600
  v_max3_f32 v29, v29, v141, v142
  v_mfma_f32_16x16x32_bf16 v[160:163], v[220:223], v[96:99], v[160:163]
  ds_read_b64_tr_b16 v[244:245], v27 offset:24576
  v_max3_f32 v29, v29, v143, v128
  v_max3_f32 v29, v29, v129, v130
  v_mfma_f32_16x16x32_bf16 v[164:167], v[220:223], v[112:115], v[164:167]
  ds_read_b64_tr_b16 v[246:247], v27 offset:25600
  v_max3_f32 v29, v29, v131, v144
  v_mfma_f32_16x16x32_bf16 v[168:171], v[224:227], v[96:99], v[168:171]
  s_waitcnt vmcnt(12)
  s_barrier
  ds_read_b128 v[216:219], v16 offset:0
  v_mfma_f32_16x16x32_bf16 v[172:175], v[224:227], v[112:115], v[172:175]
  v_max3_f32 v29, v29, v145, v146
  v_max3_f32 v29, v29, v147, v132
  v_max3_f32 v29, v29, v133, v134
  v_mfma_f32_16x16x32_bf16 v[80:83], v[248:251], v[96:99], v[80:83]
  s_waitcnt lgkmcnt(5)
  s_add_u32 m0, s30, 98304
  s_cmp_lt_u32 s50, 0x80000
  ds_read_b128 v[220:223], v17 offset:0
  v_mfma_f32_16x16x32_bf16 v[176:179], v[228:231], v[96:99], v[176:179]
  s_cselect_b32 s22, 0x80000, 0
  buffer_load_dwordx4 v12, s[20:23], s50 offen offset:0 nt lds
  v_mfma_f32_16x16x32_bf16 v[180:183], v[228:231], v[112:115], v[180:183]
  buffer_load_dwordx4 v12, s[20:23], s50 offen offset:1024 nt lds
  ds_read_b128 v[224:227], v18 offset:0
  v_mfma_f32_16x16x32_bf16 v[184:187], v[232:235], v[96:99], v[184:187]
  buffer_load_dwordx4 v13, s[20:23], s50 offen offset:2048 nt lds
  v_max3_f32 v29, v29, v135, v148
  v_mfma_f32_16x16x32_bf16 v[188:191], v[232:235], v[112:115], v[188:191]
  buffer_load_dwordx4 v13, s[20:23], s50 offen offset:3072 nt lds
  ds_read_b128 v[228:231], v19 offset:0
  v_mfma_f32_16x16x32_bf16 v[192:195], v[236:239], v[96:99], v[192:195]
  s_add_u32 s50, s50, 0x4000
  s_add_u32 m0, s30, 49152
  v_max3_f32 v29, v29, v149, v150
  v_mfma_f32_16x16x32_bf16 v[196:199], v[236:239], v[112:115], v[196:199]
  s_cmp_lt_u32 s49, 0x80000
  s_cselect_b32 s18, 0x80000, 0
  ds_read_b128 v[232:235], v16 offset:1024
  v_mfma_f32_16x16x32_bf16 v[84:87], v[248:251], v[112:115], v[84:87]
  s_waitcnt lgkmcnt(5)
  buffer_load_dwordx4 v10, s[16:19], s49 offen offset:0 nt lds
  v_mfma_f32_16x16x32_bf16 v[200:203], v[240:243], v[96:99], v[200:203]
  buffer_load_dwordx4 v10, s[16:19], s49 offen offset:1024 nt lds
  ds_read_b128 v[236:239], v17 offset:1024
  v_max_f32 v29, v29, v151
  v_mfma_f32_16x16x32_bf16 v[204:207], v[240:243], v[112:115], v[204:207]
  buffer_load_dwordx4 v11, s[16:19], s49 offen offset:2048 nt lds
  v_cmp_lt_f32 vcc, s51, v29
  v_mfma_f32_16x16x32_bf16 v[208:211], v[244:247], v[96:99], v[208:211]
  buffer_load_dwordx4 v11, s[16:19], s49 offen offset:3072 nt lds
  s_add_u32 s49, s49, 0x4000
  ds_read_b128 v[240:243], v18 offset:1024
  v_mfma_f32_16x16x32_bf16 v[212:215], v[244:247], v[112:115], v[212:215]
  s_cbranch_vccnz L_rare2
L_rare2_ret:
  s_cmp_lg_u32 s33, 0
  s_cbranch_scc1 L_wba1
  ds_read_b64_tr_b16 a[0:1], v28 offset:0
  ds_read_b64_tr_b16 a[2:3], v28 offset:4096
  ds_read_b64_tr_b16 a[4:5], v28 offset:8
  ds_read_b64_tr_b16 a[6:7], v28 offset:4104
  ds_read_b64_tr_b16 a[8:9], v28 offset:8192
  ds_read_b64_tr_b16 a[10:11], v28 offset:12288
  ds_read_b64_tr_b16 a[12:13], v28 offset:8200
  ds_read_b64_tr_b16 a[14:15], v28 offset:12296
  ds_read_b64_tr_b16 a[16:17], v28 offset:16384
  ds_read_b64_tr_b16 a[18:19], v28 offset:20480
  ds_read_b64_tr_b16 a[20:21], v28 offset:16392
  ds_read_b64_tr_b16 a[22:23], v28 offset:20488
  ds_read_b64_tr_b16 a[24:25], v28 offset:24576
  ds_read_b64_tr_b16 a[26:27], v28 offset:28672
  ds_read_b64_tr_b16 a[28:29], v28 offset:24584
  ds_read_b64_tr_b16 a[30:31], v28 offset:28680
  s_waitcnt lgkmcnt(0)
  s_branch L_wbdonea
L_wba1:
  s_cmp_lg_u32 s33, 1
  s_cbranch_scc1 L_wba2
  ds_read_b64_tr_b16 a[32:33], v28 offset:0
  ds_read_b64_tr_b16 a[34:35], v28 offset:4096
  ds_read_b64_tr_b16 a[36:37], v28 offset:8
  ds_read_b64_tr_b16 a[38:39], v28 offset:4104
  ds_read_b64_tr_b16 a[40:41], v28 offset:8192
  ds_read_b64_tr_b16 a[42:43], v28 offset:12288
  ds_read_b64_tr_b16 a[44:45], v28 offset:8200
  ds_read_b64_tr_b16 a[46:47], v28 offset:12296
  ds_read_b64_tr_b16 a[48:49], v28 offset:16384
  ds_read_b64_tr_b16 a[50:51], v28 offset:20480
  ds_read_b64_tr_b16 a[52:53], v28 offset:16392
  ds_read_b64_tr_b16 a[54:55], v28 offset:20488
  ds_read_b64_tr_b16 a[56:57], v28 offset:24576
  ds_read_b64_tr_b16 a[58:59], v28 offset:28672
  ds_read_b64_tr_b16 a[60:61], v28 offset:24584
  ds_read_b64_tr_b16 a[62:63], v28 offset:28680
  s_waitcnt lgkmcnt(0)
  s_branch L_wbdonea
L_wba2:
  s_cmp_lg_u32 s33, 2
  s_cbranch_scc1 L_wba3
  ds_read_b64_tr_b16 a[64:65], v28 offset:0
  ds_read_b64_tr_b16 a[66:67], v28 offset:4096
  ds_read_b64_tr_b16 a[68:69], v28 offset:8
  ds_read_b64_tr_b16 a[70:71], v28 offset:4104
  ds_read_b64_tr_b16 a[72:73], v28 offset:8192
  ds_read_b64_tr_b16 a[74:75], v28 offset:12288
  ds_read_b64_tr_b16 a[76:77], v28 offset:8200
  ds_read_b64_tr_b16 a[78:79], v28 offset:12296
  ds_read_b64_tr_b16 a[80:81], v28 offset:16384
  ds_read_b64_tr_b16 a[82:83], v28 offset:20480
  ds_read_b64_tr_b16 a[84:85], v28 offset:16392
  ds_read_b64_tr_b16 a[86:87], v28 offset:20488
  ds_read_b64_tr_b16 a[88:89], v28 offset:24576
  ds_read_b64_tr_b16 a[90:91], v28 offset:28672
  ds_read_b64_tr_b16 a[92:93], v28 offset:24584
  ds_read_b64_tr_b16 a[94:95], v28 offset:28680
  s_waitcnt lgkmcnt(0)
  s_branch L_wbdonea
L_wba3:
  s_cmp_lg_u32 s33, 3
  s_cbranch_scc1 L_wba4
  ds_read_b64_tr_b16 a[96:97], v28 offset:0
  ds_read_b64_tr_b16 a[98:99], v28 offset:4096
  ds_read_b64_tr_b16 a[100:101], v28 offset:8
  ds_read_b64_tr_b16 a[102:103], v28 offset:4104
  ds_read_b64_tr_b16 a[104:105], v28 offset:8192
  ds_read_b64_tr_b16 a[106:107], v28 offset:12288
  ds_read_b64_tr_b16 a[108:109], v28 offset:8200
  ds_read_b64_tr_b16 a[110:111], v28 offset:12296
  ds_read_b64_tr_b16 a[112:113], v28 offset:16384
  ds_read_b64_tr_b16 a[114:115], v28 offset:20480
  ds_read_b64_tr_b16 a[116:117], v28 offset:16392
  ds_read_b64_tr_b16 a[118:119], v28 offset:20488
  ds_read_b64_tr_b16 a[120:121], v28 offset:24576
  ds_read_b64_tr_b16 a[122:123], v28 offset:28672
  ds_read_b64_tr_b16 a[124:125], v28 offset:24584
  ds_read_b64_tr_b16 a[126:127], v28 offset:28680
  s_waitcnt lgkmcnt(0)
  s_branch L_wbdonea
L_wba4:
  s_cmp_lg_u32 s33, 4
  s_cbranch_scc1 L_wba5
  ds_read_b64_tr_b16 a[128:129], v28 offset:0
  ds_read_b64_tr_b16 a[130:131], v28 offset:4096
  ds_read_b64_tr_b16 a[132:133], v28 offset:8
  ds_read_b64_tr_b16 a[134:135], v28 offset:4104
  ds_read_b64_tr_b16 a[136:137], v28 offset:8192
  ds_read_b64_tr_b16 a[138:139], v28 offset:12288
  ds_read_b64_tr_b16 a[140:141], v28 offset:8200
  ds_read_b64_tr_b16 a[142:143], v28 offset:12296
  ds_read_b64_tr_b16 a[144:145], v28 offset:16384
  ds_read_b64_tr_b16 a[146:147], v28 offset:20480
  ds_read_b64_tr_b16 a[148:149], v28 offset:16392
  ds_read_b64_tr_b16 a[150:151], v28 offset:20488
  ds_read_b64_tr_b16 a[152:153], v28 offset:24576
  ds_read_b64_tr_b16 a[154:155], v28 offset:28672
  ds_read_b64_tr_b16 a[156:157], v28 offset:24584
  ds_read_b64_tr_b16 a[158:159], v28 offset:28680
  s_waitcnt lgkmcnt(0)
  s_branch L_wbdonea
L_wba5:
  s_cmp_lg_u32 s33, 5
  s_cbranch_scc1 L_wba6
  ds_read_b64_tr_b16 a[160:161], v28 offset:0
  ds_read_b64_tr_b16 a[162:163], v28 offset:4096
  ds_read_b64_tr_b16 a[164:165], v28 offset:8
  ds_read_b64_tr_b16 a[166:167], v28 offset:4104
  ds_read_b64_tr_b16 a[168:169], v28 offset:8192
  ds_read_b64_tr_b16 a[170:171], v28 offset:12288
  ds_read_b64_tr_b16 a[172:173], v28 offset:8200
  ds_read_b64_tr_b16 a[174:175], v28 offset:12296
  ds_read_b64_tr_b16 a[176:177], v28 offset:16384
  ds_read_b64_tr_b16 a[178:179], v28 offset:20480
  ds_read_b64_tr_b16 a[180:181], v28 offset:16392
  ds_read_b64_tr_b16 a[182:183], v28 offset:20488
  ds_read_b64_tr_b16 a[184:185], v28 offset:24576
  ds_read_b64_tr_b16 a[186:187], v28 offset:28672
  ds_read_b64_tr_b16 a[188:189], v28 offset:24584
  ds_read_b64_tr_b16 a[190:191], v28 offset:28680
  s_waitcnt lgkmcnt(0)
  s_branch L_wbdonea
L_wba6:
  ds_read_b64_tr_b16 a[192:193], v28 offset:0
  ds_read_b64_tr_b16 a[194:195], v28 offset:4096
  ds_read_b64_tr_b16 a[196:197], v28 offset:8
  ds_read_b64_tr_b16 a[198:199], v28 offset:4104
  ds_read_b64_tr_b16 a[200:201], v28 offset:8192
  ds_read_b64_tr_b16 a[202:203], v28 offset:12288
  ds_read_b64_tr_b16 a[204:205], v28 offset:8200
  ds_read_b64_tr_b16 a[206:207], v28 offset:12296
  ds_read_b64_tr_b16 a[208:209], v28 offset:16384
  ds_read_b64_tr_b16 a[210:211], v28 offset:20480
  ds_read_b64_tr_b16 a[212:213], v28 offset:16392
  ds_read_b64_tr_b16 a[214:215], v28 offset:20488
  ds_read_b64_tr_b16 a[216:217], v28 offset:24576
  ds_read_b64_tr_b16 a[218:219], v28 offset:28672
  ds_read_b64_tr_b16 a[220:221], v28 offset:24584
  ds_read_b64_tr_b16 a[222:223], v28 offset:28680
  s_waitcnt lgkmcnt(0)
L_wbdonea:
  s_waitcnt lgkmcnt(4)
  v_mfma_f32_16x16x32_bf16 v[88:91], v[216:219], v[40:43], v[72:75]
  ds_read_b128 v[244:247], v19 offset:1024
  v_exp_f32 v120, v120
  v_mfma_f32_16x16x32_bf16 v[104:107], v[216:219], v[44:47], v[76:79]
  v_exp_f32 v121, v121
  v_mfma_f32_16x16x32_bf16 v[88:91], v[220:223], v[48:51], v[88:91]
  ds_read_b128 v[216:219], v16 offset:8192
  v_exp_f32 v122, v122
  v_mfma_f32_16x16x32_bf16 v[104:107], v[220:223], v[52:55], v[104:107]
  v_exp_f32 v123, v123
  v_cvt_pk_bf16_f32 v120, v120, v121
  v_mfma_f32_16x16x32_bf16 v[88:91], v[224:227], v[56:59], v[88:91]
  ds_read_b128 v[220:223], v17 offset:8192
  v_cvt_pk_bf16_f32 v121, v122, v123
  v_mfma_f32_16x16x32_bf16 v[104:107], v[224:227], v[60:63], v[104:107]
  s_waitcnt lgkmcnt(4)
  v_exp_f32 v124, v124
  v_mfma_f32_16x16x32_bf16 v[88:91], v[228:231], v[64:67], v[88:91]
  ds_read_b128 v[224:227], v18 offset:8192
  v_exp_f32 v125, v125
  v_mfma_f32_16x16x32_bf16 v[104:107], v[228:231], v[68:71], v[104:107]
  v_exp_f32 v126, v126
  v_mfma_f32_16x16x32_bf16 v[92:95], v[232:235], v[40:43], v[72:75]
  ds_read_b128 v[228:231], v19 offset:8192
  v_exp_f32 v127, v127
  v_mfma_f32_16x16x32_bf16 v[108:111], v[232:235], v[44:47], v[76:79]
  v_cvt_pk_bf16_f32 v122, v124, v125
  v_cvt_pk_bf16_f32 v123, v126, v127
  v_mfma_f32_16x16x32_bf16 v[92:95], v[236:239], v[48:51], v[92:95]
  ds_read_b128 v[232:235], v16 offset:9216
  v_exp_f32 v136, v136
  v_mfma_f32_16x16x32_bf16 v[108:111], v[236:239], v[52:55], v[108:111]
  s_waitcnt lgkmcnt(4)
  v_mfma_f32_16x16x32_bf16 v[92:95], v[240:243], v[56:59], v[92:95]
  ds_read_b128 v[236:239], v17 offset:9216
  v_exp_f32 v137, v137
  v_mfma_f32_16x16x32_bf16 v[108:111], v[240:243], v[60:63], v[108:111]
  v_exp_f32 v138, v138
  v_mfma_f32_16x16x32_bf16 v[92:95], v[244:247], v[64:67], v[92:95]
  ds_read_b128 v[240:243], v18 offset:9216
  v_exp_f32 v139, v139
  v_mfma_f32_16x16x32_bf16 v[108:111], v[244:247], v[68:71], v[108:111]
  v_cvt_pk_bf16_f32 v136, v136, v137
  v_cvt_pk_bf16_f32 v137, v138, v139
  v_mfma_f32_16x16x32_bf16 v[96:99], v[216:219], v[40:43], v[72:75]
  ds_read_b128 v[244:247], v19 offset:9216
  v_exp_f32 v140, v140
  v_mfma_f32_16x16x32_bf16 v[112:115], v[216:219], v[44:47], v[76:79]
  s_waitcnt lgkmcnt(4)
  v_exp_f32 v141, v141
  v_mfma_f32_16x16x32_bf16 v[96:99], v[220:223], v[48:51], v[96:99]
  ds_read_b64_tr_b16 v[216:217], v20 offset:32768
  v_exp_f32 v142, v142
  v_mfma_f32_16x16x32_bf16 v[112:115], v[220:223], v[52:55], v[112:115]
  ds_read_b64_tr_b16 v[218:219], v20 offset:33792
  v_exp_f32 v143, v143
  v_mfma_f32_16x16x32_bf16 v[96:99], v[224:227], v[56:59], v[96:99]
  ds_read_b64_tr_b16 v[220:221], v21 offset:32768
  v_cvt_pk_bf16_f32 v138, v140, v141
  v_cvt_pk_bf16_f32 v139, v142, v143
  v_mfma_f32_16x16x32_bf16 v[112:115], v[224:227], v[60:63], v[112:115]
  ds_read_b64_tr_b16 v[222:223], v21 offset:33792
  v_mfma_f32_16x16x32_bf16 v[96:99], v[228:231], v[64:67], v[96:99]
  ds_read_b64_tr_b16 v[224:225], v22 offset:32768
  v_exp_f32 v128, v128
  v_mfma_f32_16x16x32_bf16 v[112:115], v[228:231], v[68:71], v[112:115]
  s_waitcnt lgkmcnt(6)
  ds_read_b64_tr_b16 v[226:227], v22 offset:33792
  v_mfma_f32_16x16x32_bf16 v[100:103], v[232:235], v[40:43], v[72:75]
  v_exp_f32 v129, v129
  v_mfma_f32_16x16x32_bf16 v[116:119], v[232:235], v[44:47], v[76:79]
  ds_read_b64_tr_b16 v[228:229], v23 offset:32768
  v_exp_f32 v130, v130
  v_mfma_f32_16x16x32_bf16 v[100:103], v[236:239], v[48:51], v[100:103]
  ds_read_b64_tr_b16 v[230:231], v23 offset:33792
  v_exp_f32 v131, v131
  v_mfma_f32_16x16x32_bf16 v[116:119], v[236:239], v[52:55], v[116:119]
  ds_read_b64_tr_b16 v[232:233], v24 offset:32768
  v_cvt_pk_bf16_f32 v128, v128, v129
  v_cvt_pk_bf16_f32 v129, v130, v131
  v_mfma_f32_16x16x32_bf16 v[100:103], v[240:243], v[56:59], v[100:103]
  ds_read_b64_tr_b16 v[234:235], v24 offset:33792
  v_exp_f32 v132, v132
  v_mfma_f32_16x16x32_bf16 v[116:119], v[240:243], v[60:63], v[116:119]
  s_waitcnt lgkmcnt(6)
  ds_read_b64_tr_b16 v[236:237], v25 offset:32768
  v_mfma_f32_16x16x32_bf16 v[100:103], v[244:247], v[64:67], v[100:103]
  ds_read_b64_tr_b16 v[238:239], v25 offset:33792
  v_exp_f32 v133, v133
  v_mfma_f32_16x16x32_bf16 v[116:119], v[244:247], v[68:71], v[116:119]
  v_exp_f32 v134, v134
  v_mfma_f32_16x16x32_bf16 v[152:155], v[216:219], v[120:123], v[152:155]
  ds_read_b64_tr_b16 v[240:241], v26 offset:32768
  v_exp_f32 v135, v135
  v_mfma_f32_16x16x32_bf16 v[156:159], v[216:219], v[136:139], v[156:159]
  ds_read_b64_tr_b16 v[242:243], v26 offset:33792
  v_cvt_pk_bf16_f32 v130, v132, v133
  v_cvt_pk_bf16_f32 v131, v134, v135
  v_mfma_f32_16x16x32_bf16 v[160:163], v[220:223], v[120:123], v[160:163]
  ds_read_b64_tr_b16 v[244:245], v27 offset:32768
  v_exp_f32 v144, v144
  v_mfma_f32_16x16x32_bf16 v[164:167], v[220:223], v[136:139], v[164:167]
  s_waitcnt lgkmcnt(5)
  ds_read_b64_tr_b16 v[246:247], v27 offset:33792
  v_mfma_f32_16x16x32_bf16 v[168:171], v[224:227], v[120:123], v[168:171]
  ds_read_b64_tr_b16 v[216:217], v20 offset:40960
  v_exp_f32 v145, v145
  v_mfma_f32_16x16x32_bf16 v[172:175], v[224:227], v[136:139], v[172:175]
  ds_read_b64_tr_b16 v[218:219], v20 offset:41984
  v_mfma_f32_16x16x32_bf16 v[80:83], v[248:251], v[120:123], v[80:83]
  ds_read_b64_tr_b16 v[220:221], v21 offset:40960
  v_exp_f32 v146, v146
  v_mfma_f32_16x16x32_bf16 v[176:179], v[228:231], v[120:123], v[176:179]
  ds_read_b64_tr_b16 v[222:223], v21 offset:41984
  v_exp_f32 v147, v147
  v_mfma_f32_16x16x32_bf16 v[180:183], v[228:231], v[136:139], v[180:183]
  ds_read_b64_tr_b16 v[224:225], v22 offset:40960
  v_cvt_pk_bf16_f32 v144, v144, v145
  v_cvt_pk_bf16_f32 v145, v146, v147
  v_mfma_f32_16x16x32_bf16 v[184:187], v[232:235], v[120:123], v[184:187]
  ds_read_b64_tr_b16 v[226:227], v22 offset:41984
  v_exp_f32 v148, v148
  v_mfma_f32_16x16x32_bf16 v[188:191], v[232:235], v[136:139], v[188:191]
  s_waitcnt lgkmcnt(6)
  v_mfma_f32_16x16x32_bf16 v[192:195], v[236:239], v[120:123], v[192:195]
  ds_read_b64_tr_b16 v[228:229], v23 offset:40960
  v_exp_f32 v149, v149
  v_mfma_f32_16x16x32_bf16 v[196:199], v[236:239], v[136:139], v[196:199]
  ds_read_b64_tr_b16 v[230:231], v23 offset:41984
  v_exp_f32 v150, v150
  v_mfma_f32_16x16x32_bf16 v[84:87], v[248:251], v[136:139], v[84:87]
  ds_read_b64_tr_b16 v[232:233], v24 offset:40960
  v_exp_f32 v151, v151
  v_mfma_f32_16x16x32_bf16 v[200:203], v[240:243], v[120:123], v[200:203]
  ds_read_b64_tr_b16 v[234:235], v24 offset:41984
  v_cvt_pk_bf16_f32 v146, v148, v149
  v_mfma_f32_16x16x32_bf16 v[204:207], v[240:243], v[136:139], v[204:207]
  ds_read_b64_tr_b16 v[236:237], v25 offset:40960
  v_cvt_pk_bf16_f32 v147, v150, v151
  v_max3_f32 v29, v88, v89, v90
  v_mfma_f32_16x16x32_bf16 v[208:211], v[244:247], v[120:123], v[208:211]
  ds_read_b64_tr_b16 v[238:239], v25 offset:41984
  v_max3_f32 v29, v29, v91, v104
  v_max3_f32 v29, v29, v105, v106
  v_mfma_f32_16x16x32_bf16 v[212:215], v[244:247], v[136:139], v[212:215]
  s_waitcnt lgkmcnt(6)
  v_max3_f32 v29, v29, v107, v92
  v_mfma_f32_16x16x32_bf16 v[152:155], v[216:219], v[128:131], v[152:155]
  ds_read_b64_tr_b16 v[240:241], v26 offset:40960
  v_max3_f32 v29, v29, v93, v94
  v_max3_f32 v29, v29, v95, v108
  v_mfma_f32_16x16x32_bf16 v[156:159], v[216:219], v[144:147], v[156:159]
  ds_read_b64_tr_b16 v[242:243], v26 offset:41984
  v_max3_f32 v29, v29, v109, v110
  v_mfma_f32_16x16x32_bf16 v[160:163], v[220:223], v[128:131], v[160:163]
  ds_read_b64_tr_b16 v[244:245], v27 offset:40960
  v_max3_f32 v29, v29, v111, v96
  v_max3_f32 v29, v29, v97, v98
  v_mfma_f32_16x16x32_bf16 v[164:167], v[220:223], v[144:147], v[164:167]
  ds_read_b64_tr_b16 v[246:247], v27 offset:41984
  v_max3_f32 v29, v29, v99, v112
  v_mfma_f32_16x16x32_bf16 v[168:171], v[224:227], v[128:131], v[168:171]
  s_waitcnt vmcnt(12)
  s_barrier
  ds_read_b128 v[216:219], v16 offset:16384
  v_mfma_f32_16x16x32_bf16 v[172:175], v[224:227], v[144:147], v[172:175]
  v_max3_f32 v29, v29, v113, v114
  v_max3_f32 v29, v29, v115, v100
  v_max3_f32 v29, v29, v101, v102
  v_mfma_f32_16x16x32_bf16 v[80:83], v[248:251], v[128:131], v[80:83]
  s_waitcnt lgkmcnt(5)
  s_add_u32 m0, s30, 114688
  s_cmp_lt_u32 s50, 0x80000
  ds_read_b128 v[220:223], v17 offset:16384
  v_mfma_f32_16x16x32_bf16 v[176:179], v[228:231], v[128:131], v[176:179]
  s_cselect_b32 s22, 0x80000, 0
  buffer_load_dwordx4 v12, s[20:23], s50 offen offset:0 nt lds
  v_mfma_f32_16x16x32_bf16 v[180:183], v[228:231], v[144:147], v[180:183]
  buffer_load_dwordx4 v12, s[20:23], s50 offen offset:1024 nt lds
  ds_read_b128 v[224:227], v18 offset:16384
  v_mfma_f32_16x16x32_bf16 v[184:187], v[232:235], v[128:131], v[184:187]
  buffer_load_dwordx4 v13, s[20:23], s50 offen offset:2048 nt lds
  v_max3_f32 v29, v29, v103, v116
  v_mfma_f32_16x16x32_bf16 v[188:191], v[232:235], v[144:147], v[188:191]
  buffer_load_dwordx4 v13, s[20:23], s50 offen offset:3072 nt lds
  ds_read_b128 v[228:231], v19 offset:16384
  v_mfma_f32_16x16x32_bf16 v[192:195], v[236:239], v[128:131], v[192:195]
  s_add_u32 s50, s50, 0x4000
  s_add_u32 m0, s30, 0
  v_max3_f32 v29, v29, v117, v118
  v_mfma_f32_16x16x32_bf16 v[196:199], v[236:239], v[144:147], v[196:199]
  s_cmp_lt_u32 s49, 0x80000
  s_cselect_b32 s18, 0x80000, 0
  ds_read_b128 v[232:235], v16 offset:17408
  v_mfma_f32_16x16x32_bf16 v[84:87], v[248:251], v[144:147], v[84:87]
  s_waitcnt lgkmcnt(5)
  buffer_load_dwordx4 v10, s[16:19], s49 offen offset:0 nt lds
  v_mfma_f32_16x16x32_bf16 v[200:203], v[240:243], v[128:131], v[200:203]
  buffer_load_dwordx4 v10, s[16:19], s49 offen offset:1024 nt lds
  ds_read_b128 v[236:239], v17 offset:17408
  v_max_f32 v29, v29, v119
  v_mfma_f32_16x16x32_bf16 v[204:207], v[240:243], v[144:147], v[204:207]
  buffer_load_dwordx4 v11, s[16:19], s49 offen offset:2048 nt lds
  v_cmp_lt_f32 vcc, s51, v29
  v_mfma_f32_16x16x32_bf16 v[208:211], v[244:247], v[128:131], v[208:211]
  buffer_load_dwordx4 v11, s[16:19], s49 offen offset:3072 nt lds
  s_add_u32 s49, s49, 0x4000
  ds_read_b128 v[240:243], v18 offset:17408
  v_mfma_f32_16x16x32_bf16 v[212:215], v[244:247], v[144:147], v[212:215]
  s_cbranch_vccnz L_rare3
L_rare3_ret:
  s_add_u32 s33, s33, 1
  s_branch L_at
L_at_last:
  s_mov_b32 s76, 0
L_init:
  v_readfirstlane_b32 s3, v38
  s_add_u32 s76, s76, 1
  s_cmp_ge_u32 s3, 256
  s_cbranch_scc1 L_init_ok
  s_cmp_ge_u32 s76, 32768
  s_cbranch_scc1 L_init_ok
  v_mov_b32 v39, 0
  buffer_load_dword v38, v39, s[64:67], 0 offen sc1
  s_waitcnt vmcnt(0)
  s_branch L_init
L_init_ok:
  s_lshl_b32 s3, s35, 20
  s_lshl_b32 s4, s55, 16
  s_add_u32 s7, s3, s4
  s_lshl_b32 s3, s29, 2
  s_lshr_b32 s3, s97, s3
  s_bfe_u32 s4, s3, 0x30004
  s_bfe_u32 s6, s3, 0x30010
  v_mov_b32 v2, s4
  v_mov_b32 v3, s6
  v_cmp_gt_u32 vcc, 4, v1
  s_lshl_b32 s4, s4, 13
  s_add_u32 s36, s4, s7
  s_lshl_b32 s6, s6, 13
  s_add_u32 s37, s6, s7
  v_cndmask_b32 v3, v3, v2, vcc
  v_and_b32 v2, 3, v1
  v_lshlrev_b32 v2, 2, v2
  v_lshl_add_u32 v3, v3, 8, v2
  v_add_u32 v4, s55, v1
  v_and_b32 v4, 3, v4
  v_lshlrev_b32 v4, 2, v4
  s_mov_b32 s40, s24
  s_mov_b32 s41, s25
  s_mov_b32 s42, 0
  s_mov_b32 s43, 0x00020000
  s_mov_b32 s8, s24
  s_mov_b32 s9, s25
  s_mov_b32 s10, 0
  s_mov_b32 s11, 0x00020000
  s_cmp_eq_u32 s29, 3
  s_cselect_b32 s38, 0, 0x2000000
  s_cselect_b32 s39, 0, 15
  s_lshl_b32 s5, s30, 1
  s_lshl_b32 s6, s55, 14
  s_add_u32 s6, s6, s81
  s_lshl_b32 s3, s29, 18
  s_add_u32 s3, s3, s7
  s_lshl_b32 s4, s54, 13
  s_add_u32 s48, s3, s4
  s_waitcnt lgkmcnt(4)
  v_mfma_f32_16x16x32_bf16 v[120:123], v[216:219], v[40:43], v[72:75]
  ds_read_b128 v[244:247], v19 offset:50176
  v_exp_f32 v88, v88
  v_mfma_f32_16x16x32_bf16 v[136:139], v[216:219], v[44:47], v[76:79]
  v_exp_f32 v89, v89
  v_mfma_f32_16x16x32_bf16 v[120:123], v[220:223], v[48:51], v[120:123]
  ds_read_b128 v[216:219], v16 offset:57344
  v_exp_f32 v90, v90
  v_mfma_f32_16x16x32_bf16 v[136:139], v[220:223], v[52:55], v[136:139]
  v_exp_f32 v91, v91
  v_mfma_f32_16x16x32_bf16 v[120:123], v[224:227], v[56:59], v[120:123]
  ds_read_b128 v[220:223], v17 offset:57344
  v_cvt_pk_bf16_f32 v88, v88, v89
  v_cvt_pk_bf16_f32 v89, v90, v91
  v_mfma_f32_16x16x32_bf16 v[136:139], v[224:227], v[60:63], v[136:139]
  s_waitcnt lgkmcnt(4)
  v_mfma_f32_16x16x32_bf16 v[120:123], v[228:231], v[64:67], v[120:123]
  ds_read_b128 v[224:227], v18 offset:57344
  v_exp_f32 v92, v92
  v_mfma_f32_16x16x32_bf16 v[136:139], v[228:231], v[68:71], v[136:139]
  v_exp_f32 v93, v93
  v_mfma_f32_16x16x32_bf16 v[124:127], v[232:235], v[40:43], v[72:75]
  ds_read_b128 v[228:231], v19 offset:57344
  v_exp_f32 v94, v94
  v_mfma_f32_16x16x32_bf16 v[140:143], v[232:235], v[44:47], v[76:79]
  v_exp_f32 v95, v95
  v_cvt_pk_bf16_f32 v90, v92, v93
  v_mfma_f32_16x16x32_bf16 v[124:127], v[236:239], v[48:51], v[124:127]
  ds_read_b128 v[232:235], v16 offset:58368
  v_cvt_pk_bf16_f32 v91, v94, v95
  v_mfma_f32_16x16x32_bf16 v[140:143], v[236:239], v[52:55], v[140:143]
  s_waitcnt lgkmcnt(4)
  v_exp_f32 v104, v104
  v_mfma_f32_16x16x32_bf16 v[124:127], v[240:243], v[56:59], v[124:127]
  ds_read_b128 v[236:239], v17 offset:58368
  v_mfma_f32_16x16x32_bf16 v[140:143], v[240:243], v[60:63], v[140:143]
  v_exp_f32 v105, v105
  v_mfma_f32_16x16x32_bf16 v[124:127], v[244:247], v[64:67], v[124:127]
  ds_read_b128 v[240:243], v18 offset:58368
  v_exp_f32 v106, v106
  v_mfma_f32_16x16x32_bf16 v[140:143], v[244:247], v[68:71], v[140:143]
  v_exp_f32 v107, v107
  v_cvt_pk_bf16_f32 v104, v104, v105
  v_mfma_f32_16x16x32_bf16 v[128:131], v[216:219], v[40:43], v[72:75]
  ds_read_b128 v[244:247], v19 offset:58368
  v_cvt_pk_bf16_f32 v105, v106, v107
  v_mfma_f32_16x16x32_bf16 v[144:147], v[216:219], v[44:47], v[76:79]
  s_waitcnt lgkmcnt(4)
  v_exp_f32 v108, v108
  v_mfma_f32_16x16x32_bf16 v[128:131], v[220:223], v[48:51], v[128:131]
  ds_read_b64_tr_b16 v[216:217], v20 offset:16384
  v_exp_f32 v109, v109
  v_mfma_f32_16x16x32_bf16 v[144:147], v[220:223], v[52:55], v[144:147]
  ds_read_b64_tr_b16 v[218:219], v20 offset:17408
  v_exp_f32 v110, v110
  v_mfma_f32_16x16x32_bf16 v[128:131], v[224:227], v[56:59], v[128:131]
  ds_read_b64_tr_b16 v[220:221], v21 offset:16384
  v_mfma_f32_16x16x32_bf16 v[144:147], v[224:227], v[60:63], v[144:147]
  ds_read_b64_tr_b16 v[222:223], v21 offset:17408
  v_exp_f32 v111, v111
  v_mfma_f32_16x16x32_bf16 v[128:131], v[228:231], v[64:67], v[128:131]
  ds_read_b64_tr_b16 v[224:225], v22 offset:16384
  v_cvt_pk_bf16_f32 v106, v108, v109
  v_cvt_pk_bf16_f32 v107, v110, v111
  v_mfma_f32_16x16x32_bf16 v[144:147], v[228:231], v[68:71], v[144:147]
  s_waitcnt lgkmcnt(6)
  ds_read_b64_tr_b16 v[226:227], v22 offset:17408
  v_mfma_f32_16x16x32_bf16 v[132:135], v[232:235], v[40:43], v[72:75]
  v_exp_f32 v96, v96
  v_mfma_f32_16x16x32_bf16 v[148:151], v[232:235], v[44:47], v[76:79]
  ds_read_b64_tr_b16 v[228:229], v23 offset:16384
  v_exp_f32 v97, v97
  v_mfma_f32_16x16x32_bf16 v[132:135], v[236:239], v[48:51], v[132:135]
  ds_read_b64_tr_b16 v[230:231], v23 offset:17408
  v_exp_f32 v98, v98
  v_mfma_f32_16x16x32_bf16 v[148:151], v[236:239], v[52:55], v[148:151]
  ds_read_b64_tr_b16 v[232:233], v24 offset:16384
  v_mfma_f32_16x16x32_bf16 v[132:135], v[240:243], v[56:59], v[132:135]
  ds_read_b64_tr_b16 v[234:235], v24 offset:17408
  v_exp_f32 v99, v99
  v_mfma_f32_16x16x32_bf16 v[148:151], v[240:243], v[60:63], v[148:151]
  s_waitcnt lgkmcnt(6)
  ds_read_b64_tr_b16 v[236:237], v25 offset:16384
  v_cvt_pk_bf16_f32 v96, v96, v97
  v_cvt_pk_bf16_f32 v97, v98, v99
  v_mfma_f32_16x16x32_bf16 v[132:135], v[244:247], v[64:67], v[132:135]
  ds_read_b64_tr_b16 v[238:239], v25 offset:17408
  v_exp_f32 v100, v100
  v_mfma_f32_16x16x32_bf16 v[148:151], v[244:247], v[68:71], v[148:151]
  v_exp_f32 v101, v101
  v_mfma_f32_16x16x32_bf16 v[152:155], v[216:219], v[88:91], v[152:155]
  ds_read_b64_tr_b16 v[240:241], v26 offset:16384
  v_mfma_f32_16x16x32_bf16 v[156:159], v[216:219], v[104:107], v[156:159]
  ds_read_b64_tr_b16 v[242:243], v26 offset:17408
  v_exp_f32 v102, v102
  v_mfma_f32_16x16x32_bf16 v[160:163], v[220:223], v[88:91], v[160:163]
  ds_read_b64_tr_b16 v[244:245], v27 offset:16384
  v_exp_f32 v103, v103
  v_mfma_f32_16x16x32_bf16 v[164:167], v[220:223], v[104:107], v[164:167]
  s_waitcnt lgkmcnt(5)
  ds_read_b64_tr_b16 v[246:247], v27 offset:17408
  v_exp_f32 v112, v112
  v_cvt_pk_bf16_f32 v98, v100, v101
  v_cvt_pk_bf16_f32 v99, v102, v103
  v_mfma_f32_16x16x32_bf16 v[168:171], v[224:227], v[88:91], v[168:171]
  ds_read_b64_tr_b16 v[216:217], v20 offset:24576
  v_mfma_f32_16x16x32_bf16 v[172:175], v[224:227], v[104:107], v[172:175]
  ds_read_b64_tr_b16 v[218:219], v20 offset:25600
  v_exp_f32 v113, v113
  v_mfma_f32_16x16x32_bf16 v[80:83], v[248:251], v[88:91], v[80:83]
  ds_read_b64_tr_b16 v[220:221], v21 offset:24576
  v_exp_f32 v114, v114
  v_mfma_f32_16x16x32_bf16 v[176:179], v[228:231], v[88:91], v[176:179]
  ds_read_b64_tr_b16 v[222:223], v21 offset:25600
  v_mfma_f32_16x16x32_bf16 v[180:183], v[228:231], v[104:107], v[180:183]
  ds_read_b64_tr_b16 v[224:225], v22 offset:24576
  v_exp_f32 v115, v115
  v_mfma_f32_16x16x32_bf16 v[184:187], v[232:235], v[88:91], v[184:187]
  ds_read_b64_tr_b16 v[226:227], v22 offset:25600
  v_exp_f32 v116, v116
  v_cvt_pk_bf16_f32 v112, v112, v113
  v_cvt_pk_bf16_f32 v113, v114, v115
  v_mfma_f32_16x16x32_bf16 v[188:191], v[232:235], v[104:107], v[188:191]
  s_waitcnt lgkmcnt(6)
  v_mfma_f32_16x16x32_bf16 v[192:195], v[236:239], v[88:91], v[192:195]
  ds_read_b64_tr_b16 v[228:229], v23 offset:24576
  v_exp_f32 v117, v117
  v_mfma_f32_16x16x32_bf16 v[196:199], v[236:239], v[104:107], v[196:199]
  ds_read_b64_tr_b16 v[230:231], v23 offset:25600
  v_exp_f32 v118, v118
  v_mfma_f32_16x16x32_bf16 v[84:87], v[248:251], v[104:107], v[84:87]
  ds_read_b64_tr_b16 v[232:233], v24 offset:24576
  v_max3_f32 v29, v120, v121, v122
  v_mfma_f32_16x16x32_bf16 v[200:203], v[240:243], v[88:91], v[200:203]
  ds_read_b64_tr_b16 v[234:235], v24 offset:25600
  v_exp_f32 v119, v119
  v_mfma_f32_16x16x32_bf16 v[204:207], v[240:243], v[104:107], v[204:207]
  ds_read_b64_tr_b16 v[236:237], v25 offset:24576
  v_cvt_pk_bf16_f32 v114, v116, v117
  v_cvt_pk_bf16_f32 v115, v118, v119
  v_mfma_f32_16x16x32_bf16 v[208:211], v[244:247], v[88:91], v[208:211]
  ds_read_b64_tr_b16 v[238:239], v25 offset:25600
  v_max3_f32 v29, v29, v123, v136
  v_mfma_f32_16x16x32_bf16 v[212:215], v[244:247], v[104:107], v[212:215]
  s_waitcnt lgkmcnt(6)
  v_max3_f32 v29, v29, v137, v138
  v_mfma_f32_16x16x32_bf16 v[152:155], v[216:219], v[96:99], v[152:155]
  ds_read_b64_tr_b16 v[240:241], v26 offset:24576
  v_max3_f32 v29, v29, v139, v124
  v_mfma_f32_16x16x32_bf16 v[156:159], v[216:219], v[112:115], v[156:159]
  ds_read_b64_tr_b16 v[242:243], v26 offset:25600
  v_max3_f32 v29, v29, v125, v126
  v_mfma_f32_16x16x32_bf16 v[160:163], v[220:223], v[96:99], v[160:163]
  ds_read_b64_tr_b16 v[244:245], v27 offset:24576
  v_max3_f32 v29, v29, v127, v140
  v_mfma_f32_16x16x32_bf16 v[164:167], v[220:223], v[112:115], v[164:167]
  ds_read_b64_tr_b16 v[246:247], v27 offset:25600
  v_max3_f32 v29, v29, v141, v142
  v_mfma_f32_16x16x32_bf16 v[168:171], v[224:227], v[96:99], v[168:171]
  s_waitcnt vmcnt(0)
  s_barrier
  ds_read_b64_tr_b16 v[216:217], v20 offset:32768
  v_mfma_f32_16x16x32_bf16 v[172:175], v[224:227], v[112:115], v[172:175]
  ds_read_b64_tr_b16 v[218:219], v20 offset:33792
  v_max3_f32 v29, v29, v143, v128
  v_mfma_f32_16x16x32_bf16 v[80:83], v[248:251], v[96:99], v[80:83]
  s_waitcnt lgkmcnt(6)
  ds_read_b64_tr_b16 v[220:221], v21 offset:32768
  v_mfma_f32_16x16x32_bf16 v[176:179], v[228:231], v[96:99], v[176:179]
  ds_read_b64_tr_b16 v[222:223], v21 offset:33792
L_pq0:
  s_mov_b64 exec, 255
  buffer_load_dword v39, v3, s[24:27], s74 offen sc1
  s_mov_b64 exec, s[78:79]
  v_mfma_f32_16x16x32_bf16 v[180:183], v[228:231], v[112:115], v[180:183]
  ds_read_b64_tr_b16 v[224:225], v22 offset:32768
  v_max3_f32 v29, v29, v129, v130
  v_mfma_f32_16x16x32_bf16 v[184:187], v[232:235], v[96:99], v[184:187]
  ds_read_b64_tr_b16 v[226:227], v22 offset:33792
  v_max3_f32 v29, v29, v131, v144
  v_mfma_f32_16x16x32_bf16 v[188:191], v[232:235], v[112:115], v[188:191]
  v_max3_f32 v29, v29, v145, v146
  v_max3_f32 v29, v29, v147, v132
  v_mfma_f32_16x16x32_bf16 v[192:195], v[236:239], v[96:99], v[192:195]
  ds_read_b64_tr_b16 v[228:229], v23 offset:32768
  v_max3_f32 v29, v29, v133, v134
  v_mfma_f32_16x16x32_bf16 v[196:199], v[236:239], v[112:115], v[196:199]
  ds_read_b64_tr_b16 v[230:231], v23 offset:33792
  v_max3_f32 v29, v29, v135, v148
  v_mfma_f32_16x16x32_bf16 v[84:87], v[248:251], v[112:115], v[84:87]
  s_waitcnt lgkmcnt(8)
  ds_read_b64_tr_b16 v[232:233], v24 offset:32768
  v_mfma_f32_16x16x32_bf16 v[200:203], v[240:243], v[96:99], v[200:203]
  ds_read_b64_tr_b16 v[234:235], v24 offset:33792
  v_max3_f32 v29, v29, v149, v150
  v_mfma_f32_16x16x32_bf16 v[204:207], v[240:243], v[112:115], v[204:207]
  ds_read_b64_tr_b16 v[236:237], v25 offset:32768
  v_max_f32 v29, v29, v151
  v_mfma_f32_16x16x32_bf16 v[208:211], v[244:247], v[96:99], v[208:211]
  ds_read_b64_tr_b16 v[238:239], v25 offset:33792
  v_cmp_lt_f32 vcc, s51, v29
  v_mfma_f32_16x16x32_bf16 v[212:215], v[244:247], v[112:115], v[212:215]
  s_cbranch_vccnz L_rare2p
L_rare2p_ret:
  ds_read_b64_tr_b16 a[224:225], v28 offset:0
  ds_read_b64_tr_b16 a[226:227], v28 offset:4096
  ds_read_b64_tr_b16 a[228:229], v28 offset:8
  ds_read_b64_tr_b16 a[230:231], v28 offset:4104
  ds_read_b64_tr_b16 a[232:233], v28 offset:8192
  ds_read_b64_tr_b16 a[234:235], v28 offset:12288
  ds_read_b64_tr_b16 a[236:237], v28 offset:8200
  ds_read_b64_tr_b16 a[238:239], v28 offset:12296
  ds_read_b64_tr_b16 a[240:241], v28 offset:16384
  ds_read_b64_tr_b16 a[242:243], v28 offset:20480
  ds_read_b64_tr_b16 a[244:245], v28 offset:16392
  ds_read_b64_tr_b16 a[246:247], v28 offset:20488
  ds_read_b64_tr_b16 a[248:249], v28 offset:24576
  ds_read_b64_tr_b16 a[250:251], v28 offset:28672
  ds_read_b64_tr_b16 a[252:253], v28 offset:24584
  ds_read_b64_tr_b16 a[254:255], v28 offset:28680
  s_waitcnt lgkmcnt(0)
  v_exp_f32 v120, v120
  v_exp_f32 v121, v121
  v_exp_f32 v122, v122
  v_exp_f32 v123, v123
  v_cvt_pk_bf16_f32 v120, v120, v121
  v_cvt_pk_bf16_f32 v121, v122, v123
  v_exp_f32 v124, v124
  v_exp_f32 v125, v125
  v_exp_f32 v126, v126
  v_exp_f32 v127, v127
  v_cvt_pk_bf16_f32 v122, v124, v125
  v_cvt_pk_bf16_f32 v123, v126, v127
  v_exp_f32 v136, v136
  v_exp_f32 v137, v137
  v_exp_f32 v138, v138
  v_exp_f32 v139, v139
  v_cvt_pk_bf16_f32 v136, v136, v137
  v_cvt_pk_bf16_f32 v137, v138, v139
  v_exp_f32 v140, v140
  v_exp_f32 v141, v141
  v_exp_f32 v142, v142
  v_exp_f32 v143, v143
  v_cvt_pk_bf16_f32 v138, v140, v141
  v_cvt_pk_bf16_f32 v139, v142, v143
  s_waitcnt lgkmcnt(6)
  v_mfma_f32_16x16x32_bf16 v[152:155], v[216:219], v[120:123], v[152:155]
  ds_read_b64_tr_b16 v[240:241], v26 offset:32768
  v_exp_f32 v128, v128
  v_mfma_f32_16x16x32_bf16 v[156:159], v[216:219], v[136:139], v[156:159]
  ds_read_b64_tr_b16 v[242:243], v26 offset:33792
  v_mfma_f32_16x16x32_bf16 v[160:163], v[220:223], v[120:123], v[160:163]
  ds_read_b64_tr_b16 v[244:245], v27 offset:32768
  v_exp_f32 v129, v129
  v_mfma_f32_16x16x32_bf16 v[164:167], v[220:223], v[136:139], v[164:167]
  ds_read_b64_tr_b16 v[246:247], v27 offset:33792
  v_exp_f32 v130, v130
  v_mfma_f32_16x16x32_bf16 v[168:171], v[224:227], v[120:123], v[168:171]
  ds_read_b64_tr_b16 v[216:217], v20 offset:40960
  v_exp_f32 v131, v131
  v_mfma_f32_16x16x32_bf16 v[172:175], v[224:227], v[136:139], v[172:175]
  ds_read_b64_tr_b16 v[218:219], v20 offset:41984
  v_cvt_pk_bf16_f32 v128, v128, v129
  v_mfma_f32_16x16x32_bf16 v[80:83], v[248:251], v[120:123], v[80:83]
  s_waitcnt lgkmcnt(6)
  ds_read_b64_tr_b16 v[220:221], v21 offset:40960
  v_cvt_pk_bf16_f32 v129, v130, v131
  v_mfma_f32_16x16x32_bf16 v[176:179], v[228:231], v[120:123], v[176:179]
  ds_read_b64_tr_b16 v[222:223], v21 offset:41984
  v_mfma_f32_16x16x32_bf16 v[180:183], v[228:231], v[136:139], v[180:183]
  ds_read_b64_tr_b16 v[224:225], v22 offset:40960
  v_exp_f32 v132, v132
  v_mfma_f32_16x16x32_bf16 v[184:187], v[232:235], v[120:123], v[184:187]
  ds_read_b64_tr_b16 v[226:227], v22 offset:41984
  v_exp_f32 v133, v133
  v_mfma_f32_16x16x32_bf16 v[188:191], v[232:235], v[136:139], v[188:191]
  v_exp_f32 v134, v134
  v_mfma_f32_16x16x32_bf16 v[192:195], v[236:239], v[120:123], v[192:195]
  ds_read_b64_tr_b16 v[228:229], v23 offset:40960
  v_exp_f32 v135, v135
  v_mfma_f32_16x16x32_bf16 v[196:199], v[236:239], v[136:139], v[196:199]
  ds_read_b64_tr_b16 v[230:231], v23 offset:41984
  v_cvt_pk_bf16_f32 v130, v132, v133
  v_mfma_f32_16x16x32_bf16 v[84:87], v[248:251], v[136:139], v[84:87]
  s_waitcnt lgkmcnt(6)
  ds_read_b64_tr_b16 v[232:233], v24 offset:40960
  v_cvt_pk_bf16_f32 v131, v134, v135
  v_mfma_f32_16x16x32_bf16 v[200:203], v[240:243], v[120:123], v[200:203]
  ds_read_b64_tr_b16 v[234:235], v24 offset:41984
L_pt0:
  s_waitcnt vmcnt(0)
  v_cmp_ne_u32 vcc, 1, v39
  s_nop 1
  s_and_b32 s98, vcc_lo, s39
  s_cselect_b32 s42, 0, s38
  v_mfma_f32_16x16x32_bf16 v[204:207], v[240:243], v[136:139], v[204:207]
  s_add_u32 s3, s55, 1
  s_and_b32 s3, s3, 3
  ds_read_b64_tr_b16 v[236:237], v25 offset:40960
  v_exp_f32 v144, v144
  v_exp_f32 v145, v145
  v_exp_f32 v146, v146
  v_exp_f32 v147, v147
  v_exp_f32 v148, v148
  v_exp_f32 v149, v149
  v_exp_f32 v150, v150
  v_exp_f32 v151, v151
  v_cvt_pk_bf16_f32 v144, v144, v145
  v_cvt_pk_bf16_f32 v145, v146, v147
  v_cvt_pk_bf16_f32 v146, v148, v149
  v_cvt_pk_bf16_f32 v147, v150, v151
  v_mfma_f32_16x16x32_bf16 v[208:211], v[244:247], v[120:123], v[208:211]
  s_lshl_b32 s3, s3, 18
  s_add_u32 s46, s3, s36
  ds_read_b64_tr_b16 v[238:239], v25 offset:41984
  v_mfma_f32_16x16x32_bf16 v[212:215], v[244:247], v[136:139], v[212:215]
  s_add_u32 m0, s5, 0
  s_add_u32 s47, s46, 4096
  v_mfma_f32_16x16x32_bf16 v[152:155], v[216:219], v[128:131], v[152:155]
  buffer_load_dwordx4 v15, s[40:43], s46 offen offset:0 sc1 lds
  ds_read_b64_tr_b16 v[240:241], v26 offset:40960
  v_mfma_f32_16x16x32_bf16 v[156:159], v[216:219], v[144:147], v[156:159]
  s_waitcnt lgkmcnt(5)
  ds_read_b64_tr_b16 v[242:243], v26 offset:41984
  v_mfma_f32_16x16x32_bf16 v[160:163], v[220:223], v[128:131], v[160:163]
  buffer_load_dwordx4 v15, s[40:43], s46 offen offset:1024 sc1 lds
  ds_read_b64_tr_b16 v[244:245], v27 offset:40960
  v_mfma_f32_16x16x32_bf16 v[164:167], v[220:223], v[144:147], v[164:167]
  ds_read_b64_tr_b16 v[246:247], v27 offset:41984
  v_mfma_f32_16x16x32_bf16 v[168:171], v[224:227], v[128:131], v[168:171]
  buffer_load_dwordx4 v15, s[40:43], s46 offen offset:2048 sc1 lds
  v_mfma_f32_16x16x32_bf16 v[172:175], v[224:227], v[144:147], v[172:175]
  v_mfma_f32_16x16x32_bf16 v[80:83], v[248:251], v[128:131], v[80:83]
  buffer_load_dwordx4 v15, s[40:43], s46 offen offset:3072 sc1 lds
  v_mfma_f32_16x16x32_bf16 v[176:179], v[228:231], v[128:131], v[176:179]
  v_mfma_f32_16x16x32_bf16 v[180:183], v[228:231], v[144:147], v[180:183]
  s_waitcnt lgkmcnt(2)
  s_add_u32 m0, m0, 4096
  s_nop 0
  v_mfma_f32_16x16x32_bf16 v[184:187], v[232:235], v[128:131], v[184:187]
  buffer_load_dwordx4 v15, s[40:43], s47 offen offset:0 sc1 lds
  v_mfma_f32_16x16x32_bf16 v[188:191], v[232:235], v[144:147], v[188:191]
  v_mfma_f32_16x16x32_bf16 v[192:195], v[236:239], v[128:131], v[192:195]
  buffer_load_dwordx4 v15, s[40:43], s47 offen offset:1024 sc1 lds
  v_mfma_f32_16x16x32_bf16 v[196:199], v[236:239], v[144:147], v[196:199]
  v_mfma_f32_16x16x32_bf16 v[84:87], v[248:251], v[144:147], v[84:87]
  buffer_load_dwordx4 v15, s[40:43], s47 offen offset:2048 sc1 lds
  v_mfma_f32_16x16x32_bf16 v[200:203], v[240:243], v[128:131], v[200:203]
  v_mfma_f32_16x16x32_bf16 v[204:207], v[240:243], v[144:147], v[204:207]
  s_waitcnt lgkmcnt(0)
  buffer_load_dwordx4 v15, s[40:43], s47 offen offset:3072 sc1 lds
  v_mfma_f32_16x16x32_bf16 v[208:211], v[244:247], v[128:131], v[208:211]
  v_mfma_f32_16x16x32_bf16 v[212:215], v[244:247], v[144:147], v[212:215]
  s_add_u32 s80, s48, 4096
  v_add_u32 v2, s5, v15
  v_add_u32 v2, 0x8000, v2
  v_rcp_f32 v6, v80
  v_rcp_f32 v8, v84
  s_nop 0
  v_mov_b32 v7, v6
  v_mov_b32 v9, v8
  v_pk_mul_f32 v[152:153], v[152:153], v[6:7]
  v_pk_mul_f32 v[154:155], v[154:155], v[6:7]
  v_pk_mul_f32 v[160:161], v[160:161], v[6:7]
  v_pk_mul_f32 v[162:163], v[162:163], v[6:7]
  v_cvt_pk_bf16_f32 v40, v152, v153
  v_cvt_pk_bf16_f32 v41, v154, v155
  v_cvt_pk_bf16_f32 v42, v160, v161
  v_cvt_pk_bf16_f32 v43, v162, v163
  buffer_store_dwordx4 v[40:43], v15, s[24:27], s48 offen offset:0 sc1
  v_pk_mul_f32 v[156:157], v[156:157], v[8:9]
  v_pk_mul_f32 v[158:159], v[158:159], v[8:9]
  v_pk_mul_f32 v[164:165], v[164:165], v[8:9]
  v_pk_mul_f32 v[166:167], v[166:167], v[8:9]
  v_cvt_pk_bf16_f32 v56, v156, v157
  v_cvt_pk_bf16_f32 v57, v158, v159
  v_cvt_pk_bf16_f32 v58, v164, v165
  v_cvt_pk_bf16_f32 v59, v166, v167
  buffer_store_dwordx4 v[56:59], v15, s[24:27], s80 offen offset:0 sc1
  v_pk_mul_f32 v[168:169], v[168:169], v[6:7]
  v_pk_mul_f32 v[170:171], v[170:171], v[6:7]
  v_pk_mul_f32 v[176:177], v[176:177], v[6:7]
  v_pk_mul_f32 v[178:179], v[178:179], v[6:7]
  v_cvt_pk_bf16_f32 v44, v168, v169
  v_cvt_pk_bf16_f32 v45, v170, v171
  v_cvt_pk_bf16_f32 v46, v176, v177
  v_cvt_pk_bf16_f32 v47, v178, v179
  buffer_store_dwordx4 v[44:47], v15, s[24:27], s48 offen offset:1024 sc1
  v_pk_mul_f32 v[172:173], v[172:173], v[8:9]
  v_pk_mul_f32 v[174:175], v[174:175], v[8:9]
  v_pk_mul_f32 v[180:181], v[180:181], v[8:9]
  v_pk_mul_f32 v[182:183], v[182:183], v[8:9]
  v_cvt_pk_bf16_f32 v60, v172, v173
  v_cvt_pk_bf16_f32 v61, v174, v175
  v_cvt_pk_bf16_f32 v62, v180, v181
  v_cvt_pk_bf16_f32 v63, v182, v183
  buffer_store_dwordx4 v[60:63], v15, s[24:27], s80 offen offset:1024 sc1
  v_pk_mul_f32 v[184:185], v[184:185], v[6:7]
  v_pk_mul_f32 v[186:187], v[186:187], v[6:7]
  v_pk_mul_f32 v[192:193], v[192:193], v[6:7]
  v_pk_mul_f32 v[194:195], v[194:195], v[6:7]
  v_cvt_pk_bf16_f32 v48, v184, v185
  v_cvt_pk_bf16_f32 v49, v186, v187
  v_cvt_pk_bf16_f32 v50, v192, v193
  v_cvt_pk_bf16_f32 v51, v194, v195
  buffer_store_dwordx4 v[48:51], v15, s[24:27], s48 offen offset:2048 sc1
  v_pk_mul_f32 v[188:189], v[188:189], v[8:9]
  v_pk_mul_f32 v[190:191], v[190:191], v[8:9]
  v_pk_mul_f32 v[196:197], v[196:197], v[8:9]
  v_pk_mul_f32 v[198:199], v[198:199], v[8:9]
  v_cvt_pk_bf16_f32 v64, v188, v189
  v_cvt_pk_bf16_f32 v65, v190, v191
  v_cvt_pk_bf16_f32 v66, v196, v197
  v_cvt_pk_bf16_f32 v67, v198, v199
  buffer_store_dwordx4 v[64:67], v15, s[24:27], s80 offen offset:2048 sc1
  v_pk_mul_f32 v[200:201], v[200:201], v[6:7]
  v_pk_mul_f32 v[202:203], v[202:203], v[6:7]
  v_pk_mul_f32 v[208:209], v[208:209], v[6:7]
  v_pk_mul_f32 v[210:211], v[210:211], v[6:7]
  v_cvt_pk_bf16_f32 v52, v200, v201
  v_cvt_pk_bf16_f32 v53, v202, v203
  v_cvt_pk_bf16_f32 v54, v208, v209
  v_cvt_pk_bf16_f32 v55, v210, v211
  buffer_store_dwordx4 v[52:55], v15, s[24:27], s48 offen offset:3072 sc1
  v_pk_mul_f32 v[204:205], v[204:205], v[8:9]
  v_pk_mul_f32 v[206:207], v[206:207], v[8:9]
  v_pk_mul_f32 v[212:213], v[212:213], v[8:9]
  v_pk_mul_f32 v[214:215], v[214:215], v[8:9]
  v_cvt_pk_bf16_f32 v68, v204, v205
  v_cvt_pk_bf16_f32 v69, v206, v207
  v_cvt_pk_bf16_f32 v70, v212, v213
  v_cvt_pk_bf16_f32 v71, v214, v215
  buffer_store_dwordx4 v[68:71], v15, s[24:27], s80 offen offset:3072 sc1
  ds_write_b128 v2, v[40:43] offset:0
  ds_write_b128 v2, v[56:59] offset:4096
  ds_write_b128 v2, v[44:47] offset:1024
  ds_write_b128 v2, v[60:63] offset:5120
  ds_write_b128 v2, v[48:51] offset:2048
  ds_write_b128 v2, v[64:67] offset:6144
  ds_write_b128 v2, v[52:55] offset:3072
  ds_write_b128 v2, v[68:71] offset:7168
  s_add_u32 s3, s55, 0
  s_and_b32 s3, s3, 3
  s_lshl_b32 s3, s3, 13
  v_add_u32 v16, s3, v15
  s_add_u32 s3, s55, 1
  s_and_b32 s3, s3, 3
  s_lshl_b32 s3, s3, 13
  v_add_u32 v17, s3, v15
  s_add_u32 s3, s55, 2
  s_and_b32 s3, s3, 3
  s_lshl_b32 s3, s3, 13
  v_add_u32 v18, s3, v15
  s_add_u32 s3, s55, 3
  s_and_b32 s3, s3, 3
  s_lshl_b32 s3, s3, 13
  v_add_u32 v19, s3, v15
  v_add_u32 v20, 0x10000, v15
  v_add_u32 v21, 0x20000, v15
  s_waitcnt lgkmcnt(0)
  s_barrier
  ds_read_b128 v[216:219], v16 offset:32768
  ds_read_b128 v[220:223], v16 offset:36864
  ds_read_b128 v[224:227], v17 offset:32768
  ds_read_b128 v[228:231], v17 offset:36864
  ds_read_b128 v[232:235], v18 offset:32768
  ds_read_b128 v[236:239], v18 offset:36864
  ds_read_b128 v[240:243], v19 offset:32768
  s_waitcnt lgkmcnt(5)
  v_mfma_f32_16x16x32_bf16 v[88:91], a[0:3], v[216:219], 0
  ds_read_b128 v[244:247], v19 offset:36864
  v_mfma_f32_16x16x32_bf16 v[92:95], a[4:7], v[216:219], 0
  v_mfma_f32_16x16x32_bf16 v[96:99], a[0:3], v[220:223], 0
  ds_read_b128 v[216:219], v16 offset:33792
  v_mfma_f32_16x16x32_bf16 v[100:103], a[4:7], v[220:223], 0
  s_waitcnt lgkmcnt(5)
  v_mfma_f32_16x16x32_bf16 v[104:107], a[0:3], v[224:227], 0
  ds_read_b128 v[220:223], v16 offset:37888
  v_mfma_f32_16x16x32_bf16 v[108:111], a[4:7], v[224:227], 0
  v_mfma_f32_16x16x32_bf16 v[112:115], a[0:3], v[228:231], 0
  ds_read_b128 v[224:227], v17 offset:33792
  v_mfma_f32_16x16x32_bf16 v[116:119], a[4:7], v[228:231], 0
  s_waitcnt lgkmcnt(5)
  v_mfma_f32_16x16x32_bf16 v[120:123], a[0:3], v[232:235], 0
  ds_read_b128 v[228:231], v17 offset:37888
  v_mfma_f32_16x16x32_bf16 v[124:127], a[4:7], v[232:235], 0
  v_mfma_f32_16x16x32_bf16 v[128:131], a[0:3], v[236:239], 0
  ds_read_b128 v[232:235], v18 offset:33792
  v_mfma_f32_16x16x32_bf16 v[132:135], a[4:7], v[236:239], 0
  s_waitcnt lgkmcnt(5)
  v_mfma_f32_16x16x32_bf16 v[136:139], a[0:3], v[240:243], 0
  ds_read_b128 v[236:239], v18 offset:37888
  s_waitcnt vmcnt(0)
  v_mov_b32 v38, 1
  s_mov_b64 exec, 1
  buffer_store_dword v38, v36, s[24:27], s74 offen sc1
  s_mov_b64 exec, s[78:79]
  s_cmp_eq_u32 s98, 0
  s_cbranch_scc1 L_a_ok
  s_mov_b32 s76, 0
L_pb1:
  s_mov_b64 exec, 255
  buffer_load_dword v39, v3, s[24:27], s74 offen sc1
  s_mov_b64 exec, s[78:79]
  s_waitcnt vmcnt(0)
  v_cmp_ne_u32 vcc, 1, v39
  s_nop 1
  s_and_b32 s98, vcc_lo, s39
  s_cbranch_scc0 L_pb1_out
  s_add_u32 s76, s76, 1
  s_cmp_ge_u32 s76, 32768
  s_cbranch_scc1 L_pb1_out
  s_branch L_pb1
L_pb1_out:
  s_mov_b32 s42, s38
  s_add_u32 s3, s55, 1
  s_and_b32 s3, s3, 3
  s_lshl_b32 s3, s3, 18
  s_add_u32 s46, s3, s36
  s_add_u32 m0, s5, 0
  s_add_u32 s47, s46, 4096
  buffer_load_dwordx4 v15, s[40:43], s46 offen offset:0 sc1 lds
  buffer_load_dwordx4 v15, s[40:43], s46 offen offset:1024 sc1 lds
  buffer_load_dwordx4 v15, s[40:43], s46 offen offset:2048 sc1 lds
  buffer_load_dwordx4 v15, s[40:43], s46 offen offset:3072 sc1 lds
  s_add_u32 m0, m0, 4096
  s_nop 0
  buffer_load_dwordx4 v15, s[40:43], s47 offen offset:0 sc1 lds
  buffer_load_dwordx4 v15, s[40:43], s47 offen offset:1024 sc1 lds
  buffer_load_dwordx4 v15, s[40:43], s47 offen offset:2048 sc1 lds
  buffer_load_dwordx4 v15, s[40:43], s47 offen offset:3072 sc1 lds
L_a_ok:
  v_mfma_f32_16x16x32_bf16 v[140:143], a[4:7], v[240:243], 0
  s_add_u32 s3, s55, 2
  s_and_b32 s3, s3, 3
  v_mfma_f32_16x16x32_bf16 v[144:147], a[0:3], v[244:247], 0
  s_lshl_b32 s3, s3, 18
  s_add_u32 s46, s3, s36
  ds_read_b128 v[240:243], v19 offset:33792
  v_mfma_f32_16x16x32_bf16 v[148:151], a[4:7], v[244:247], 0
  s_waitcnt lgkmcnt(5)
  s_add_u32 m0, s5, 65536
  s_add_u32 s47, s46, 4096
  v_mfma_f32_16x16x32_bf16 v[88:91], a[8:11], v[216:219], v[88:91]
  buffer_load_dwordx4 v15, s[40:43], s46 offen offset:0 sc1 lds
  ds_read_b128 v[244:247], v19 offset:37888
  v_mfma_f32_16x16x32_bf16 v[92:95], a[12:15], v[216:219], v[92:95]
  v_mfma_f32_16x16x32_bf16 v[96:99], a[8:11], v[220:223], v[96:99]
  buffer_load_dwordx4 v15, s[40:43], s46 offen offset:1024 sc1 lds
  ds_read_b128 v[216:219], v16 offset:34816
  v_mfma_f32_16x16x32_bf16 v[100:103], a[12:15], v[220:223], v[100:103]
  s_waitcnt lgkmcnt(5)
  v_mfma_f32_16x16x32_bf16 v[104:107], a[8:11], v[224:227], v[104:107]
  buffer_load_dwordx4 v15, s[40:43], s46 offen offset:2048 sc1 lds
  ds_read_b128 v[220:223], v16 offset:38912
  v_mfma_f32_16x16x32_bf16 v[108:111], a[12:15], v[224:227], v[108:111]
  v_mfma_f32_16x16x32_bf16 v[112:115], a[8:11], v[228:231], v[112:115]
  buffer_load_dwordx4 v15, s[40:43], s46 offen offset:3072 sc1 lds
  ds_read_b128 v[224:227], v17 offset:34816
  v_mfma_f32_16x16x32_bf16 v[116:119], a[12:15], v[228:231], v[116:119]
  s_waitcnt lgkmcnt(5)
  v_mfma_f32_16x16x32_bf16 v[120:123], a[8:11], v[232:235], v[120:123]
  s_add_u32 m0, m0, 4096
  s_nop 0
  ds_read_b128 v[228:231], v17 offset:38912
  v_mfma_f32_16x16x32_bf16 v[124:127], a[12:15], v[232:235], v[124:127]
  buffer_load_dwordx4 v15, s[40:43], s47 offen offset:0 sc1 lds
  v_mfma_f32_16x16x32_bf16 v[128:131], a[8:11], v[236:239], v[128:131]
  ds_read_b128 v[232:235], v18 offset:34816
  v_mfma_f32_16x16x32_bf16 v[132:135], a[12:15], v[236:239], v[132:135]
  s_waitcnt lgkmcnt(5)
  buffer_load_dwordx4 v15, s[40:43], s47 offen offset:1024 sc1 lds
  v_mfma_f32_16x16x32_bf16 v[136:139], a[8:11], v[240:243], v[136:139]
  ds_read_b128 v[236:239], v18 offset:38912
  v_mfma_f32_16x16x32_bf16 v[140:143], a[12:15], v[240:243], v[140:143]
  buffer_load_dwordx4 v15, s[40:43], s47 offen offset:2048 sc1 lds
  v_mfma_f32_16x16x32_bf16 v[144:147], a[8:11], v[244:247], v[144:147]
  ds_read_b128 v[240:243], v19 offset:34816
  v_mfma_f32_16x16x32_bf16 v[148:151], a[12:15], v[244:247], v[148:151]
  s_waitcnt lgkmcnt(5)
  buffer_load_dwordx4 v15, s[40:43], s47 offen offset:3072 sc1 lds
  v_mfma_f32_16x16x32_bf16 v[88:91], a[16:19], v[216:219], v[88:91]
  ds_read_b128 v[244:247], v19 offset:38912
  v_mfma_f32_16x16x32_bf16 v[92:95], a[20:23], v[216:219], v[92:95]
  v_mfma_f32_16x16x32_bf16 v[96:99], a[16:19], v[220:223], v[96:99]
  ds_read_b128 v[216:219], v16 offset:35840
  v_mfma_f32_16x16x32_bf16 v[100:103], a[20:23], v[220:223], v[100:103]
  s_waitcnt lgkmcnt(5)
  v_mfma_f32_16x16x32_bf16 v[104:107], a[16:19], v[224:227], v[104:107]
  ds_read_b128 v[220:223], v16 offset:39936
  v_mfma_f32_16x16x32_bf16 v[108:111], a[20:23], v[224:227], v[108:111]
  v_mfma_f32_16x16x32_bf16 v[112:115], a[16:19], v[228:231], v[112:115]
  ds_read_b128 v[224:227], v17 offset:35840
  v_mfma_f32_16x16x32_bf16 v[116:119], a[20:23], v[228:231], v[116:119]
  s_waitcnt lgkmcnt(5)
  v_mfma_f32_16x16x32_bf16 v[120:123], a[16:19], v[232:235], v[120:123]
  ds_read_b128 v[228:231], v17 offset:39936
  v_mfma_f32_16x16x32_bf16 v[124:127], a[20:23], v[232:235], v[124:127]
  v_mfma_f32_16x16x32_bf16 v[128:131], a[16:19], v[236:239], v[128:131]
  ds_read_b128 v[232:235], v18 offset:35840
  v_mfma_f32_16x16x32_bf16 v[132:135], a[20:23], v[236:239], v[132:135]
  s_waitcnt lgkmcnt(5)
  v_mfma_f32_16x16x32_bf16 v[136:139], a[16:19], v[240:243], v[136:139]
  ds_read_b128 v[236:239], v18 offset:39936
  v_mfma_f32_16x16x32_bf16 v[140:143], a[20:23], v[240:243], v[140:143]
  v_mfma_f32_16x16x32_bf16 v[144:147], a[16:19], v[244:247], v[144:147]
  ds_read_b128 v[240:243], v19 offset:35840
  v_mfma_f32_16x16x32_bf16 v[148:151], a[20:23], v[244:247], v[148:151]
  s_waitcnt lgkmcnt(5)
  v_mfma_f32_16x16x32_bf16 v[88:91], a[24:27], v[216:219], v[88:91]
  ds_read_b128 v[244:247], v19 offset:39936
  v_mfma_f32_16x16x32_bf16 v[92:95], a[28:31], v[216:219], v[92:95]
  v_mfma_f32_16x16x32_bf16 v[96:99], a[24:27], v[220:223], v[96:99]
  s_waitcnt vmcnt(8)
  s_barrier
  ds_read_b128 v[216:219], v15 offset:0
  v_mfma_f32_16x16x32_bf16 v[100:103], a[28:31], v[220:223], v[100:103]
  s_waitcnt lgkmcnt(5)
  v_mfma_f32_16x16x32_bf16 v[104:107], a[24:27], v[224:227], v[104:107]
  ds_read_b128 v[220:223], v15 offset:4096
  v_mfma_f32_16x16x32_bf16 v[108:111], a[28:31], v[224:227], v[108:111]
  v_mfma_f32_16x16x32_bf16 v[112:115], a[24:27], v[228:231], v[112:115]
  ds_read_b128 v[224:227], v15 offset:1024
  v_mfma_f32_16x16x32_bf16 v[116:119], a[28:31], v[228:231], v[116:119]
  s_waitcnt lgkmcnt(5)
  v_mfma_f32_16x16x32_bf16 v[120:123], a[24:27], v[232:235], v[120:123]
  ds_read_b128 v[228:231], v15 offset:5120
  v_mfma_f32_16x16x32_bf16 v[124:127], a[28:31], v[232:235], v[124:127]
  v_mfma_f32_16x16x32_bf16 v[128:131], a[24:27], v[236:239], v[128:131]
  ds_read_b128 v[232:235], v15 offset:2048
  v_mfma_f32_16x16x32_bf16 v[132:135], a[28:31], v[236:239], v[132:135]
  s_waitcnt lgkmcnt(5)
  v_mfma_f32_16x16x32_bf16 v[136:139], a[24:27], v[240:243], v[136:139]
  ds_read_b128 v[236:239], v15 offset:6144
  v_mfma_f32_16x16x32_bf16 v[140:143], a[28:31], v[240:243], v[140:143]
  v_mfma_f32_16x16x32_bf16 v[144:147], a[24:27], v[244:247], v[144:147]
  ds_read_b128 v[240:243], v15 offset:3072
  v_mfma_f32_16x16x32_bf16 v[148:151], a[28:31], v[244:247], v[148:151]
  s_waitcnt lgkmcnt(5)
  v_mfma_f32_16x16x32_bf16 v[104:107], a[32:35], v[216:219], v[104:107]
  s_add_u32 s3, s55, 3
  s_and_b32 s3, s3, 3
  ds_read_b128 v[244:247], v15 offset:7168
  v_mfma_f32_16x16x32_bf16 v[108:111], a[36:39], v[216:219], v[108:111]
  s_lshl_b32 s3, s3, 18
  s_add_u32 s46, s3, s36
  v_mfma_f32_16x16x32_bf16 v[112:115], a[32:35], v[220:223], v[112:115]
  s_add_u32 m0, s5, 98304
  s_add_u32 s47, s46, 4096
  ds_read_b128 v[216:219], v15 offset:8192
  v_mfma_f32_16x16x32_bf16 v[116:119], a[36:39], v[220:223], v[116:119]
  s_waitcnt lgkmcnt(5)
  buffer_load_dwordx4 v15, s[40:43], s46 offen offset:0 sc1 lds
  v_mfma_f32_16x16x32_bf16 v[104:107], a[40:43], v[224:227], v[104:107]
  ds_read_b128 v[220:223], v15 offset:12288
  v_mfma_f32_16x16x32_bf16 v[108:111], a[44:47], v[224:227], v[108:111]
  v_mfma_f32_16x16x32_bf16 v[112:115], a[40:43], v[228:231], v[112:115]
  buffer_load_dwordx4 v15, s[40:43], s46 offen offset:1024 sc1 lds
  ds_read_b128 v[224:227], v15 offset:9216
  v_mfma_f32_16x16x32_bf16 v[116:119], a[44:47], v[228:231], v[116:119]
  s_waitcnt lgkmcnt(5)
  v_mfma_f32_16x16x32_bf16 v[104:107], a[48:51], v[232:235], v[104:107]
  ds_read_b128 v[228:231], v15 offset:13312
  v_mfma_f32_16x16x32_bf16 v[108:111], a[52:55], v[232:235], v[108:111]
  buffer_load_dwordx4 v15, s[40:43], s46 offen offset:2048 sc1 lds
  v_mfma_f32_16x16x32_bf16 v[112:115], a[48:51], v[236:239], v[112:115]
  ds_read_b128 v[232:235], v15 offset:10240
  v_mfma_f32_16x16x32_bf16 v[116:119], a[52:55], v[236:239], v[116:119]
  s_waitcnt lgkmcnt(5)
  v_mfma_f32_16x16x32_bf16 v[104:107], a[56:59], v[240:243], v[104:107]
  buffer_load_dwordx4 v15, s[40:43], s46 offen offset:3072 sc1 lds
  ds_read_b128 v[236:239], v15 offset:14336
  v_mfma_f32_16x16x32_bf16 v[108:111], a[60:63], v[240:243], v[108:111]
  v_mfma_f32_16x16x32_bf16 v[112:115], a[56:59], v[244:247], v[112:115]
  ds_read_b128 v[240:243], v15 offset:11264
  v_mfma_f32_16x16x32_bf16 v[116:119], a[60:63], v[244:247], v[116:119]
  s_waitcnt lgkmcnt(5)
  s_add_u32 m0, m0, 4096
  s_nop 0
  v_mfma_f32_16x16x32_bf16 v[104:107], a[64:67], v[216:219], v[104:107]
  buffer_load_dwordx4 v15, s[40:43], s47 offen offset:0 sc1 lds
  ds_read_b128 v[244:247], v15 offset:15360
  v_mfma_f32_16x16x32_bf16 v[108:111], a[68:71], v[216:219], v[108:111]
  v_mfma_f32_16x16x32_bf16 v[112:115], a[64:67], v[220:223], v[112:115]
  ds_read_b128 v[216:219], v15 offset:16384
  v_mfma_f32_16x16x32_bf16 v[116:119], a[68:71], v[220:223], v[116:119]
  s_waitcnt lgkmcnt(5)
  buffer_load_dwordx4 v15, s[40:43], s47 offen offset:1024 sc1 lds
  v_mfma_f32_16x16x32_bf16 v[104:107], a[72:75], v[224:227], v[104:107]
  ds_read_b128 v[220:223], v15 offset:20480
  v_mfma_f32_16x16x32_bf16 v[108:111], a[76:79], v[224:227], v[108:111]
  v_mfma_f32_16x16x32_bf16 v[112:115], a[72:75], v[228:231], v[112:115]
  buffer_load_dwordx4 v15, s[40:43], s47 offen offset:2048 sc1 lds
  ds_read_b128 v[224:227], v15 offset:17408
  v_mfma_f32_16x16x32_bf16 v[116:119], a[76:79], v[228:231], v[116:119]
  s_waitcnt lgkmcnt(5)
  v_mfma_f32_16x16x32_bf16 v[104:107], a[80:83], v[232:235], v[104:107]
  ds_read_b128 v[228:231], v15 offset:21504
  v_mfma_f32_16x16x32_bf16 v[108:111], a[84:87], v[232:235], v[108:111]
  buffer_load_dwordx4 v15, s[40:43], s47 offen offset:3072 sc1 lds
  v_mfma_f32_16x16x32_bf16 v[112:115], a[80:83], v[236:239], v[112:115]
  ds_read_b128 v[232:235], v15 offset:18432
  v_mfma_f32_16x16x32_bf16 v[116:119], a[84:87], v[236:239], v[116:119]
  s_waitcnt lgkmcnt(5)
  v_mfma_f32_16x16x32_bf16 v[104:107], a[88:91], v[240:243], v[104:107]
  ds_read_b128 v[236:239], v15 offset:22528
  v_mfma_f32_16x16x32_bf16 v[108:111], a[92:95], v[240:243], v[108:111]
  v_mfma_f32_16x16x32_bf16 v[112:115], a[88:91], v[244:247], v[112:115]
  ds_read_b128 v[240:243], v15 offset:19456
  v_mfma_f32_16x16x32_bf16 v[116:119], a[92:95], v[244:247], v[116:119]
  s_waitcnt lgkmcnt(5)
  v_mfma_f32_16x16x32_bf16 v[104:107], a[96:99], v[216:219], v[104:107]
  ds_read_b128 v[244:247], v15 offset:23552
  v_mfma_f32_16x16x32_bf16 v[108:111], a[100:103], v[216:219], v[108:111]
  v_mfma_f32_16x16x32_bf16 v[112:115], a[96:99], v[220:223], v[112:115]
  s_waitcnt vmcnt(8)
  s_barrier
  ds_read_b128 v[216:219], v20 offset:0
  v_mfma_f32_16x16x32_bf16 v[116:119], a[100:103], v[220:223], v[116:119]
  s_waitcnt lgkmcnt(5)
  v_mfma_f32_16x16x32_bf16 v[104:107], a[104:107], v[224:227], v[104:107]
  ds_read_b128 v[220:223], v20 offset:4096
  v_mfma_f32_16x16x32_bf16 v[108:111], a[108:111], v[224:227], v[108:111]
  v_mfma_f32_16x16x32_bf16 v[112:115], a[104:107], v[228:231], v[112:115]
  ds_read_b128 v[224:227], v20 offset:1024
  v_mfma_f32_16x16x32_bf16 v[116:119], a[108:111], v[228:231], v[116:119]
  s_waitcnt lgkmcnt(5)
  v_mfma_f32_16x16x32_bf16 v[104:107], a[112:115], v[232:235], v[104:107]
  ds_read_b128 v[228:231], v20 offset:5120
  v_mfma_f32_16x16x32_bf16 v[108:111], a[116:119], v[232:235], v[108:111]
  v_mfma_f32_16x16x32_bf16 v[112:115], a[112:115], v[236:239], v[112:115]
  ds_read_b128 v[232:235], v20 offset:2048
L_pq1:
  s_mov_b64 exec, 255
  buffer_load_dword v39, v3, s[24:27], s74 offen sc1
  s_mov_b64 exec, s[78:79]
  v_mfma_f32_16x16x32_bf16 v[116:119], a[116:119], v[236:239], v[116:119]
  s_waitcnt lgkmcnt(5)
  v_mfma_f32_16x16x32_bf16 v[104:107], a[120:123], v[240:243], v[104:107]
  ds_read_b128 v[236:239], v20 offset:6144
  v_mfma_f32_16x16x32_bf16 v[108:111], a[124:127], v[240:243], v[108:111]
  v_mfma_f32_16x16x32_bf16 v[112:115], a[120:123], v[244:247], v[112:115]
  ds_read_b128 v[240:243], v20 offset:3072
  v_mfma_f32_16x16x32_bf16 v[116:119], a[124:127], v[244:247], v[116:119]
  s_waitcnt lgkmcnt(5)
  v_mfma_f32_16x16x32_bf16 v[120:123], a[32:35], v[216:219], v[120:123]
  ds_read_b128 v[244:247], v20 offset:7168
  v_mfma_f32_16x16x32_bf16 v[124:127], a[36:39], v[216:219], v[124:127]
  v_mfma_f32_16x16x32_bf16 v[128:131], a[32:35], v[220:223], v[128:131]
  ds_read_b128 v[216:219], v20 offset:8192
  v_mfma_f32_16x16x32_bf16 v[132:135], a[36:39], v[220:223], v[132:135]
  s_waitcnt lgkmcnt(5)
  v_mfma_f32_16x16x32_bf16 v[120:123], a[40:43], v[224:227], v[120:123]
  ds_read_b128 v[220:223], v20 offset:12288
  v_mfma_f32_16x16x32_bf16 v[124:127], a[44:47], v[224:227], v[124:127]
  v_mfma_f32_16x16x32_bf16 v[128:131], a[40:43], v[228:231], v[128:131]
  ds_read_b128 v[224:227], v20 offset:9216
  v_mfma_f32_16x16x32_bf16 v[132:135], a[44:47], v[228:231], v[132:135]
  s_waitcnt lgkmcnt(5)
  v_mfma_f32_16x16x32_bf16 v[120:123], a[48:51], v[232:235], v[120:123]
  ds_read_b128 v[228:231], v20 offset:13312
  v_mfma_f32_16x16x32_bf16 v[124:127], a[52:55], v[232:235], v[124:127]
  v_mfma_f32_16x16x32_bf16 v[128:131], a[48:51], v[236:239], v[128:131]
  ds_read_b128 v[232:235], v20 offset:10240
L_pt1:
  s_waitcnt vmcnt(0)
  v_cmp_ne_u32 vcc, 1, v39
  s_nop 1
  s_and_b32 s99, vcc_lo, 0xf0
  s_cselect_b32 s10, 0, 0x2000000
  v_mfma_f32_16x16x32_bf16 v[132:135], a[52:55], v[236:239], v[132:135]
  s_waitcnt lgkmcnt(5)
  s_add_u32 s3, s55, 1
  s_and_b32 s3, s3, 3
  v_mfma_f32_16x16x32_bf16 v[120:123], a[56:59], v[240:243], v[120:123]
  s_lshl_b32 s3, s3, 18
  s_add_u32 s46, s3, s37
  ds_read_b128 v[236:239], v20 offset:14336
  v_mfma_f32_16x16x32_bf16 v[124:127], a[60:63], v[240:243], v[124:127]
  s_add_u32 m0, s5, 131072
  s_add_u32 s47, s46, 4096
  v_mfma_f32_16x16x32_bf16 v[128:131], a[56:59], v[244:247], v[128:131]
  buffer_load_dwordx4 v15, s[8:11], s46 offen offset:0 sc1 lds
  ds_read_b128 v[240:243], v20 offset:11264
  v_mfma_f32_16x16x32_bf16 v[132:135], a[60:63], v[244:247], v[132:135]
  s_waitcnt lgkmcnt(5)
  v_mfma_f32_16x16x32_bf16 v[120:123], a[64:67], v[216:219], v[120:123]
  buffer_load_dwordx4 v15, s[8:11], s46 offen offset:1024 sc1 lds
  ds_read_b128 v[244:247], v20 offset:15360
  v_mfma_f32_16x16x32_bf16 v[124:127], a[68:71], v[216:219], v[124:127]
  v_mfma_f32_16x16x32_bf16 v[128:131], a[64:67], v[220:223], v[128:131]
  buffer_load_dwordx4 v15, s[8:11], s46 offen offset:2048 sc1 lds
  ds_read_b128 v[216:219], v20 offset:16384
  v_mfma_f32_16x16x32_bf16 v[132:135], a[68:71], v[220:223], v[132:135]
  s_waitcnt lgkmcnt(5)
  v_mfma_f32_16x16x32_bf16 v[120:123], a[72:75], v[224:227], v[120:123]
  buffer_load_dwordx4 v15, s[8:11], s46 offen offset:3072 sc1 lds
  ds_read_b128 v[220:223], v20 offset:20480
  v_mfma_f32_16x16x32_bf16 v[124:127], a[76:79], v[224:227], v[124:127]
  v_mfma_f32_16x16x32_bf16 v[128:131], a[72:75], v[228:231], v[128:131]
  s_add_u32 m0, m0, 4096
  s_nop 0
  ds_read_b128 v[224:227], v20 offset:17408
  v_mfma_f32_16x16x32_bf16 v[132:135], a[76:79], v[228:231], v[132:135]
  s_waitcnt lgkmcnt(5)
  buffer_load_dwordx4 v15, s[8:11], s47 offen offset:0 sc1 lds
  v_mfma_f32_16x16x32_bf16 v[120:123], a[80:83], v[232:235], v[120:123]
  ds_read_b128 v[228:231], v20 offset:21504
  v_mfma_f32_16x16x32_bf16 v[124:127], a[84:87], v[232:235], v[124:127]
  buffer_load_dwordx4 v15, s[8:11], s47 offen offset:1024 sc1 lds
  v_mfma_f32_16x16x32_bf16 v[128:131], a[80:83], v[236:239], v[128:131]
  ds_read_b128 v[232:235], v20 offset:18432
  v_mfma_f32_16x16x32_bf16 v[132:135], a[84:87], v[236:239], v[132:135]
  s_waitcnt lgkmcnt(5)
  buffer_load_dwordx4 v15, s[8:11], s47 offen offset:2048 sc1 lds
  v_mfma_f32_16x16x32_bf16 v[120:123], a[88:91], v[240:243], v[120:123]
  ds_read_b128 v[236:239], v20 offset:22528
  v_mfma_f32_16x16x32_bf16 v[124:127], a[92:95], v[240:243], v[124:127]
  buffer_load_dwordx4 v15, s[8:11], s47 offen offset:3072 sc1 lds
  v_mfma_f32_16x16x32_bf16 v[128:131], a[88:91], v[244:247], v[128:131]
  ds_read_b128 v[240:243], v20 offset:19456
  v_mfma_f32_16x16x32_bf16 v[132:135], a[92:95], v[244:247], v[132:135]
  s_waitcnt lgkmcnt(5)
  v_mfma_f32_16x16x32_bf16 v[120:123], a[96:99], v[216:219], v[120:123]
  ds_read_b128 v[244:247], v20 offset:23552
  v_mfma_f32_16x16x32_bf16 v[124:127], a[100:103], v[216:219], v[124:127]
  v_mfma_f32_16x16x32_bf16 v[128:131], a[96:99], v[220:223], v[128:131]
  s_waitcnt vmcnt(8)
  s_barrier
  ds_read_b128 v[216:219], v20 offset:32768
  v_mfma_f32_16x16x32_bf16 v[132:135], a[100:103], v[220:223], v[132:135]
  s_waitcnt lgkmcnt(5)
  v_mfma_f32_16x16x32_bf16 v[120:123], a[104:107], v[224:227], v[120:123]
  ds_read_b128 v[220:223], v20 offset:36864
  v_mfma_f32_16x16x32_bf16 v[124:127], a[108:111], v[224:227], v[124:127]
  v_mfma_f32_16x16x32_bf16 v[128:131], a[104:107], v[228:231], v[128:131]
  ds_read_b128 v[224:227], v20 offset:33792
  v_mfma_f32_16x16x32_bf16 v[132:135], a[108:111], v[228:231], v[132:135]
  s_waitcnt lgkmcnt(5)
  v_mfma_f32_16x16x32_bf16 v[120:123], a[112:115], v[232:235], v[120:123]
  ds_read_b128 v[228:231], v20 offset:37888
  v_mfma_f32_16x16x32_bf16 v[124:127], a[116:119], v[232:235], v[124:127]
  v_mfma_f32_16x16x32_bf16 v[128:131], a[112:115], v[236:239], v[128:131]
  ds_read_b128 v[232:235], v20 offset:34816
  v_mfma_f32_16x16x32_bf16 v[132:135], a[116:119], v[236:239], v[132:135]
  s_waitcnt lgkmcnt(5)
  v_mfma_f32_16x16x32_bf16 v[120:123], a[120:123], v[240:243], v[120:123]
  ds_read_b128 v[236:239], v20 offset:38912
  v_mfma_f32_16x16x32_bf16 v[124:127], a[124:127], v[240:243], v[124:127]
  v_mfma_f32_16x16x32_bf16 v[128:131], a[120:123], v[244:247], v[128:131]
  ds_read_b128 v[240:243], v20 offset:35840
  v_mfma_f32_16x16x32_bf16 v[132:135], a[124:127], v[244:247], v[132:135]
  s_waitcnt lgkmcnt(5)
  v_mfma_f32_16x16x32_bf16 v[136:139], a[32:35], v[216:219], v[136:139]
  s_add_u32 s3, s55, 2
  s_and_b32 s3, s3, 3
  ds_read_b128 v[244:247], v20 offset:39936
  v_mfma_f32_16x16x32_bf16 v[140:143], a[36:39], v[216:219], v[140:143]
  s_lshl_b32 s3, s3, 18
  s_add_u32 s46, s3, s37
  v_mfma_f32_16x16x32_bf16 v[144:147], a[32:35], v[220:223], v[144:147]
  s_add_u32 m0, s5, 32768
  s_add_u32 s47, s46, 4096
  ds_read_b128 v[216:219], v20 offset:40960
  v_mfma_f32_16x16x32_bf16 v[148:151], a[36:39], v[220:223], v[148:151]
  s_waitcnt lgkmcnt(5)
  buffer_load_dwordx4 v15, s[8:11], s46 offen offset:0 sc1 lds
  v_mfma_f32_16x16x32_bf16 v[136:139], a[40:43], v[224:227], v[136:139]
  ds_read_b128 v[220:223], v20 offset:45056
  v_mfma_f32_16x16x32_bf16 v[140:143], a[44:47], v[224:227], v[140:143]
  v_mfma_f32_16x16x32_bf16 v[144:147], a[40:43], v[228:231], v[144:147]
  buffer_load_dwordx4 v15, s[8:11], s46 offen offset:1024 sc1 lds
  ds_read_b128 v[224:227], v20 offset:41984
  v_mfma_f32_16x16x32_bf16 v[148:151], a[44:47], v[228:231], v[148:151]
  s_waitcnt lgkmcnt(5)
  v_mfma_f32_16x16x32_bf16 v[136:139], a[48:51], v[232:235], v[136:139]
  ds_read_b128 v[228:231], v20 offset:46080
  v_mfma_f32_16x16x32_bf16 v[140:143], a[52:55], v[232:235], v[140:143]
  buffer_load_dwordx4 v15, s[8:11], s46 offen offset:2048 sc1 lds
  v_mfma_f32_16x16x32_bf16 v[144:147], a[48:51], v[236:239], v[144:147]
  ds_read_b128 v[232:235], v20 offset:43008
  v_mfma_f32_16x16x32_bf16 v[148:151], a[52:55], v[236:239], v[148:151]
  s_waitcnt lgkmcnt(5)
  v_mfma_f32_16x16x32_bf16 v[136:139], a[56:59], v[240:243], v[136:139]
  buffer_load_dwordx4 v15, s[8:11], s46 offen offset:3072 sc1 lds
  ds_read_b128 v[236:239], v20 offset:47104
  v_mfma_f32_16x16x32_bf16 v[140:143], a[60:63], v[240:243], v[140:143]
  v_mfma_f32_16x16x32_bf16 v[144:147], a[56:59], v[244:247], v[144:147]
  ds_read_b128 v[240:243], v20 offset:44032
  v_mfma_f32_16x16x32_bf16 v[148:151], a[60:63], v[244:247], v[148:151]
  s_waitcnt lgkmcnt(5)
  s_add_u32 m0, m0, 4096
  s_nop 0
  v_mfma_f32_16x16x32_bf16 v[136:139], a[64:67], v[216:219], v[136:139]
  buffer_load_dwordx4 v15, s[8:11], s47 offen offset:0 sc1 lds
  ds_read_b128 v[244:247], v20 offset:48128
  v_mfma_f32_16x16x32_bf16 v[140:143], a[68:71], v[216:219], v[140:143]
  v_mfma_f32_16x16x32_bf16 v[144:147], a[64:67], v[220:223], v[144:147]
  ds_read_b128 v[216:219], v20 offset:49152
  v_mfma_f32_16x16x32_bf16 v[148:151], a[68:71], v[220:223], v[148:151]
  s_waitcnt lgkmcnt(5)
  buffer_load_dwordx4 v15, s[8:11], s47 offen offset:1024 sc1 lds
  v_mfma_f32_16x16x32_bf16 v[136:139], a[72:75], v[224:227], v[136:139]
  ds_read_b128 v[220:223], v20 offset:53248
  v_mfma_f32_16x16x32_bf16 v[140:143], a[76:79], v[224:227], v[140:143]
  v_mfma_f32_16x16x32_bf16 v[144:147], a[72:75], v[228:231], v[144:147]
  buffer_load_dwordx4 v15, s[8:11], s47 offen offset:2048 sc1 lds
  ds_read_b128 v[224:227], v20 offset:50176
  v_mfma_f32_16x16x32_bf16 v[148:151], a[76:79], v[228:231], v[148:151]
  s_waitcnt lgkmcnt(5)
  v_mfma_f32_16x16x32_bf16 v[136:139], a[80:83], v[232:235], v[136:139]
  ds_read_b128 v[228:231], v20 offset:54272
  v_mfma_f32_16x16x32_bf16 v[140:143], a[84:87], v[232:235], v[140:143]
  buffer_load_dwordx4 v15, s[8:11], s47 offen offset:3072 sc1 lds
  v_mfma_f32_16x16x32_bf16 v[144:147], a[80:83], v[236:239], v[144:147]
  ds_read_b128 v[232:235], v20 offset:51200
  v_mfma_f32_16x16x32_bf16 v[148:151], a[84:87], v[236:239], v[148:151]
  s_waitcnt lgkmcnt(5)
  v_mfma_f32_16x16x32_bf16 v[136:139], a[88:91], v[240:243], v[136:139]
  ds_read_b128 v[236:239], v20 offset:55296
  v_mfma_f32_16x16x32_bf16 v[140:143], a[92:95], v[240:243], v[140:143]
  v_mfma_f32_16x16x32_bf16 v[144:147], a[88:91], v[244:247], v[144:147]
  ds_read_b128 v[240:243], v20 offset:52224
  v_mfma_f32_16x16x32_bf16 v[148:151], a[92:95], v[244:247], v[148:151]
  s_waitcnt lgkmcnt(5)
  v_mfma_f32_16x16x32_bf16 v[136:139], a[96:99], v[216:219], v[136:139]
  ds_read_b128 v[244:247], v20 offset:56320
  v_mfma_f32_16x16x32_bf16 v[140:143], a[100:103], v[216:219], v[140:143]
  v_mfma_f32_16x16x32_bf16 v[144:147], a[96:99], v[220:223], v[144:147]
  s_cmp_eq_u32 s99, 0
  s_cbranch_scc1 L_b_ok
  s_mov_b32 s76, 0
L_pb2:
  s_mov_b64 exec, 255
  buffer_load_dword v39, v3, s[24:27], s74 offen sc1
  s_mov_b64 exec, s[78:79]
  s_waitcnt vmcnt(0)
  v_cmp_ne_u32 vcc, 1, v39
  s_nop 1
  s_and_b32 s99, vcc_lo, 0xf0
  s_cbranch_scc0 L_pb2_out
  s_add_u32 s76, s76, 1
  s_cmp_ge_u32 s76, 32768
  s_cbranch_scc1 L_pb2_out
  s_branch L_pb2
L_pb2_out:
  s_mov_b32 s10, 0x2000000
  s_add_u32 s3, s55, 1
  s_and_b32 s3, s3, 3
  s_lshl_b32 s3, s3, 18
  s_add_u32 s46, s3, s37
  s_add_u32 m0, s5, 131072
  s_add_u32 s47, s46, 4096
  buffer_load_dwordx4 v15, s[8:11], s46 offen offset:0 sc1 lds
  buffer_load_dwordx4 v15, s[8:11], s46 offen offset:1024 sc1 lds
  buffer_load_dwordx4 v15, s[8:11], s46 offen offset:2048 sc1 lds
  buffer_load_dwordx4 v15, s[8:11], s46 offen offset:3072 sc1 lds
  s_add_u32 m0, m0, 4096
  s_nop 0
  buffer_load_dwordx4 v15, s[8:11], s47 offen offset:0 sc1 lds
  buffer_load_dwordx4 v15, s[8:11], s47 offen offset:1024 sc1 lds
  buffer_load_dwordx4 v15, s[8:11], s47 offen offset:2048 sc1 lds
  buffer_load_dwordx4 v15, s[8:11], s47 offen offset:3072 sc1 lds
  s_add_u32 s3, s55, 2
  s_and_b32 s3, s3, 3
  s_lshl_b32 s3, s3, 18
  s_add_u32 s46, s3, s37
  s_add_u32 m0, s5, 32768
  s_add_u32 s47, s46, 4096
  buffer_load_dwordx4 v15, s[8:11], s46 offen offset:0 sc1 lds
  buffer_load_dwordx4 v15, s[8:11], s46 offen offset:1024 sc1 lds
  buffer_load_dwordx4 v15, s[8:11], s46 offen offset:2048 sc1 lds
  buffer_load_dwordx4 v15, s[8:11], s46 offen offset:3072 sc1 lds
  s_add_u32 m0, m0, 4096
  s_nop 0
  buffer_load_dwordx4 v15, s[8:11], s47 offen offset:0 sc1 lds
  buffer_load_dwordx4 v15, s[8:11], s47 offen offset:1024 sc1 lds
  buffer_load_dwordx4 v15, s[8:11], s47 offen offset:2048 sc1 lds
  buffer_load_dwordx4 v15, s[8:11], s47 offen offset:3072 sc1 lds
L_b_ok:
  s_waitcnt vmcnt(8)
  s_barrier
  ds_read_b128 v[216:219], v21 offset:0
  v_mfma_f32_16x16x32_bf16 v[148:151], a[100:103], v[220:223], v[148:151]
  s_waitcnt lgkmcnt(5)
  v_mfma_f32_16x16x32_bf16 v[136:139], a[104:107], v[224:227], v[136:139]
  ds_read_b128 v[220:223], v21 offset:4096
  v_mfma_f32_16x16x32_bf16 v[140:143], a[108:111], v[224:227], v[140:143]
  v_mfma_f32_16x16x32_bf16 v[144:147], a[104:107], v[228:231], v[144:147]
  ds_read_b128 v[224:227], v21 offset:1024
  v_mfma_f32_16x16x32_bf16 v[148:151], a[108:111], v[228:231], v[148:151]
  s_waitcnt lgkmcnt(5)
  v_mfma_f32_16x16x32_bf16 v[136:139], a[112:115], v[232:235], v[136:139]
  ds_read_b128 v[228:231], v21 offset:5120
  v_mfma_f32_16x16x32_bf16 v[140:143], a[116:119], v[232:235], v[140:143]
  v_mfma_f32_16x16x32_bf16 v[144:147], a[112:115], v[236:239], v[144:147]
  ds_read_b128 v[232:235], v21 offset:2048
  v_mfma_f32_16x16x32_bf16 v[148:151], a[116:119], v[236:239], v[148:151]
  s_waitcnt lgkmcnt(5)
  v_mfma_f32_16x16x32_bf16 v[136:139], a[120:123], v[240:243], v[136:139]
  ds_read_b128 v[236:239], v21 offset:6144
  v_mfma_f32_16x16x32_bf16 v[140:143], a[124:127], v[240:243], v[140:143]
  v_mfma_f32_16x16x32_bf16 v[144:147], a[120:123], v[244:247], v[144:147]
  ds_read_b128 v[240:243], v21 offset:3072
  v_mfma_f32_16x16x32_bf16 v[148:151], a[124:127], v[244:247], v[148:151]
  s_waitcnt lgkmcnt(5)
  v_mfma_f32_16x16x32_bf16 v[104:107], a[128:131], v[216:219], v[104:107]
  s_add_u32 s3, s55, 3
  s_and_b32 s3, s3, 3
  ds_read_b128 v[244:247], v21 offset:7168
  v_mfma_f32_16x16x32_bf16 v[108:111], a[132:135], v[216:219], v[108:111]
  s_lshl_b32 s3, s3, 18
  s_add_u32 s46, s3, s37
  v_mfma_f32_16x16x32_bf16 v[112:115], a[128:131], v[220:223], v[112:115]
  s_add_u32 m0, s5, 0
  s_add_u32 s47, s46, 4096
  ds_read_b128 v[216:219], v21 offset:8192
  v_mfma_f32_16x16x32_bf16 v[116:119], a[132:135], v[220:223], v[116:119]
  s_waitcnt lgkmcnt(5)
  buffer_load_dwordx4 v15, s[8:11], s46 offen offset:0 sc1 lds
  v_mfma_f32_16x16x32_bf16 v[104:107], a[136:139], v[224:227], v[104:107]
  ds_read_b128 v[220:223], v21 offset:12288
  v_mfma_f32_16x16x32_bf16 v[108:111], a[140:143], v[224:227], v[108:111]
  v_mfma_f32_16x16x32_bf16 v[112:115], a[136:139], v[228:231], v[112:115]
  buffer_load_dwordx4 v15, s[8:11], s46 offen offset:1024 sc1 lds
  ds_read_b128 v[224:227], v21 offset:9216
  v_mfma_f32_16x16x32_bf16 v[116:119], a[140:143], v[228:231], v[116:119]
  s_waitcnt lgkmcnt(5)
  v_mfma_f32_16x16x32_bf16 v[104:107], a[144:147], v[232:235], v[104:107]
  ds_read_b128 v[228:231], v21 offset:13312
  v_mfma_f32_16x16x32_bf16 v[108:111], a[148:151], v[232:235], v[108:111]
  buffer_load_dwordx4 v15, s[8:11], s46 offen offset:2048 sc1 lds
  v_mfma_f32_16x16x32_bf16 v[112:115], a[144:147], v[236:239], v[112:115]
  ds_read_b128 v[232:235], v21 offset:10240
  v_mfma_f32_16x16x32_bf16 v[116:119], a[148:151], v[236:239], v[116:119]
  s_waitcnt lgkmcnt(5)
  v_mfma_f32_16x16x32_bf16 v[104:107], a[152:155], v[240:243], v[104:107]
  buffer_load_dwordx4 v15, s[8:11], s46 offen offset:3072 sc1 lds
  ds_read_b128 v[236:239], v21 offset:14336
  v_mfma_f32_16x16x32_bf16 v[108:111], a[156:159], v[240:243], v[108:111]
  v_mfma_f32_16x16x32_bf16 v[112:115], a[152:155], v[244:247], v[112:115]
  ds_read_b128 v[240:243], v21 offset:11264
  v_mfma_f32_16x16x32_bf16 v[116:119], a[156:159], v[244:247], v[116:119]
  s_waitcnt lgkmcnt(5)
  s_add_u32 m0, m0, 4096
  s_nop 0
  v_mfma_f32_16x16x32_bf16 v[104:107], a[160:163], v[216:219], v[104:107]
  buffer_load_dwordx4 v15, s[8:11], s47 offen offset:0 sc1 lds
  ds_read_b128 v[244:247], v21 offset:15360
  v_mfma_f32_16x16x32_bf16 v[108:111], a[164:167], v[216:219], v[108:111]
  v_mfma_f32_16x16x32_bf16 v[112:115], a[160:163], v[220:223], v[112:115]
  ds_read_b128 v[216:219], v21 offset:16384
  v_mfma_f32_16x16x32_bf16 v[116:119], a[164:167], v[220:223], v[116:119]
  s_waitcnt lgkmcnt(5)
  buffer_load_dwordx4 v15, s[8:11], s47 offen offset:1024 sc1 lds
  v_mfma_f32_16x16x32_bf16 v[104:107], a[168:171], v[224:227], v[104:107]
  ds_read_b128 v[220:223], v21 offset:20480
  v_mfma_f32_16x16x32_bf16 v[108:111], a[172:175], v[224:227], v[108:111]
  v_mfma_f32_16x16x32_bf16 v[112:115], a[168:171], v[228:231], v[112:115]
  buffer_load_dwordx4 v15, s[8:11], s47 offen offset:2048 sc1 lds
  ds_read_b128 v[224:227], v21 offset:17408
  v_mfma_f32_16x16x32_bf16 v[116:119], a[172:175], v[228:231], v[116:119]
  s_waitcnt lgkmcnt(5)
  v_mfma_f32_16x16x32_bf16 v[104:107], a[176:179], v[232:235], v[104:107]
  ds_read_b128 v[228:231], v21 offset:21504
  v_mfma_f32_16x16x32_bf16 v[108:111], a[180:183], v[232:235], v[108:111]
  buffer_load_dwordx4 v15, s[8:11], s47 offen offset:3072 sc1 lds
  v_mfma_f32_16x16x32_bf16 v[112:115], a[176:179], v[236:239], v[112:115]
  ds_read_b128 v[232:235], v21 offset:18432
  v_mfma_f32_16x16x32_bf16 v[116:119], a[180:183], v[236:239], v[116:119]
  s_waitcnt lgkmcnt(5)
  v_mfma_f32_16x16x32_bf16 v[104:107], a[184:187], v[240:243], v[104:107]
  ds_read_b128 v[236:239], v21 offset:22528
  v_mfma_f32_16x16x32_bf16 v[108:111], a[188:191], v[240:243], v[108:111]
  v_mfma_f32_16x16x32_bf16 v[112:115], a[184:187], v[244:247], v[112:115]
  ds_read_b128 v[240:243], v21 offset:19456
  v_mfma_f32_16x16x32_bf16 v[116:119], a[188:191], v[244:247], v[116:119]
  s_waitcnt lgkmcnt(5)
  v_mfma_f32_16x16x32_bf16 v[104:107], a[192:195], v[216:219], v[104:107]
  ds_read_b128 v[244:247], v21 offset:23552
  v_mfma_f32_16x16x32_bf16 v[108:111], a[196:199], v[216:219], v[108:111]
  v_mfma_f32_16x16x32_bf16 v[112:115], a[192:195], v[220:223], v[112:115]
  ds_read_b128 v[216:219], v21 offset:24576
  v_mfma_f32_16x16x32_bf16 v[116:119], a[196:199], v[220:223], v[116:119]
  s_waitcnt lgkmcnt(5)
  v_mfma_f32_16x16x32_bf16 v[104:107], a[200:203], v[224:227], v[104:107]
  ds_read_b128 v[220:223], v21 offset:28672
  v_mfma_f32_16x16x32_bf16 v[108:111], a[204:207], v[224:227], v[108:111]
  v_mfma_f32_16x16x32_bf16 v[112:115], a[200:203], v[228:231], v[112:115]
  ds_read_b128 v[224:227], v21 offset:25600
  v_mfma_f32_16x16x32_bf16 v[116:119], a[204:207], v[228:231], v[116:119]
  s_waitcnt lgkmcnt(5)
  v_mfma_f32_16x16x32_bf16 v[104:107], a[208:211], v[232:235], v[104:107]
  ds_read_b128 v[228:231], v21 offset:29696
  v_mfma_f32_16x16x32_bf16 v[108:111], a[212:215], v[232:235], v[108:111]
  v_mfma_f32_16x16x32_bf16 v[112:115], a[208:211], v[236:239], v[112:115]
  ds_read_b128 v[232:235], v21 offset:26624
  v_mfma_f32_16x16x32_bf16 v[116:119], a[212:215], v[236:239], v[116:119]
  s_waitcnt lgkmcnt(5)
  v_mfma_f32_16x16x32_bf16 v[104:107], a[216:219], v[240:243], v[104:107]
  ds_read_b128 v[236:239], v21 offset:30720
  v_mfma_f32_16x16x32_bf16 v[108:111], a[220:223], v[240:243], v[108:111]
  v_mfma_f32_16x16x32_bf16 v[112:115], a[216:219], v[244:247], v[112:115]
  ds_read_b128 v[240:243], v21 offset:27648
  v_mfma_f32_16x16x32_bf16 v[116:119], a[220:223], v[244:247], v[116:119]
  s_waitcnt lgkmcnt(5)
  v_mfma_f32_16x16x32_bf16 v[104:107], a[224:227], v[216:219], v[104:107]
  ds_read_b128 v[244:247], v21 offset:31744
  v_mfma_f32_16x16x32_bf16 v[108:111], a[228:231], v[216:219], v[108:111]
  v_mfma_f32_16x16x32_bf16 v[112:115], a[224:227], v[220:223], v[112:115]
  s_waitcnt vmcnt(8)
  s_barrier
  ds_read_b128 v[216:219], v15 offset:32768
  v_mfma_f32_16x16x32_bf16 v[116:119], a[228:231], v[220:223], v[116:119]
  s_waitcnt lgkmcnt(5)
  v_mfma_f32_16x16x32_bf16 v[104:107], a[232:235], v[224:227], v[104:107]
  ds_read_b128 v[220:223], v15 offset:36864
  v_mfma_f32_16x16x32_bf16 v[108:111], a[236:239], v[224:227], v[108:111]
  v_mfma_f32_16x16x32_bf16 v[112:115], a[232:235], v[228:231], v[112:115]
  ds_read_b128 v[224:227], v15 offset:33792
  v_mfma_f32_16x16x32_bf16 v[116:119], a[236:239], v[228:231], v[116:119]
  s_waitcnt lgkmcnt(5)
  v_mfma_f32_16x16x32_bf16 v[104:107], a[240:243], v[232:235], v[104:107]
  ds_read_b128 v[228:231], v15 offset:37888
  v_mfma_f32_16x16x32_bf16 v[108:111], a[244:247], v[232:235], v[108:111]
  v_mfma_f32_16x16x32_bf16 v[112:115], a[240:243], v[236:239], v[112:115]
  ds_read_b128 v[232:235], v15 offset:34816
  v_mfma_f32_16x16x32_bf16 v[116:119], a[244:247], v[236:239], v[116:119]
  s_waitcnt lgkmcnt(5)
  v_mfma_f32_16x16x32_bf16 v[104:107], a[248:251], v[240:243], v[104:107]
  ds_read_b128 v[236:239], v15 offset:38912
  v_mfma_f32_16x16x32_bf16 v[108:111], a[252:255], v[240:243], v[108:111]
  v_mfma_f32_16x16x32_bf16 v[112:115], a[248:251], v[244:247], v[112:115]
  ds_read_b128 v[240:243], v15 offset:35840
  v_mfma_f32_16x16x32_bf16 v[116:119], a[252:255], v[244:247], v[116:119]
  s_waitcnt lgkmcnt(5)
  v_mfma_f32_16x16x32_bf16 v[120:123], a[128:131], v[216:219], v[120:123]
  s_add_u32 s3, s55, 0
  s_and_b32 s3, s3, 3
  ds_read_b128 v[244:247], v15 offset:39936
  v_mfma_f32_16x16x32_bf16 v[124:127], a[132:135], v[216:219], v[124:127]
  s_lshl_b32 s3, s3, 18
  s_add_u32 s46, s3, s36
  v_mfma_f32_16x16x32_bf16 v[128:131], a[128:131], v[220:223], v[128:131]
  s_add_u32 m0, s5, 65536
  s_add_u32 s47, s46, 4096
  ds_read_b128 v[216:219], v15 offset:40960
  v_mfma_f32_16x16x32_bf16 v[132:135], a[132:135], v[220:223], v[132:135]
  s_waitcnt lgkmcnt(5)
  buffer_load_dwordx4 v15, s[40:43], s46 offen offset:0 sc1 lds
  v_mfma_f32_16x16x32_bf16 v[120:123], a[136:139], v[224:227], v[120:123]
  ds_read_b128 v[220:223], v15 offset:45056
  v_cvt_pk_bf16_f32 v48, v104, v105
  v_cvt_pk_bf16_f32 v49, v106, v107
  v_mfma_f32_16x16x32_bf16 v[124:127], a[140:143], v[224:227], v[124:127]
  v_cvt_pk_bf16_f32 v50, v108, v109
  v_cvt_pk_bf16_f32 v51, v110, v111
  v_mfma_f32_16x16x32_bf16 v[128:131], a[136:139], v[228:231], v[128:131]
  buffer_load_dwordx4 v15, s[40:43], s46 offen offset:1024 sc1 lds
  ds_read_b128 v[224:227], v15 offset:41984
  v_cvt_pk_bf16_f32 v52, v112, v113
  v_cvt_pk_bf16_f32 v53, v114, v115
  v_mfma_f32_16x16x32_bf16 v[132:135], a[140:143], v[228:231], v[132:135]
  s_waitcnt lgkmcnt(5)
  v_cvt_pk_bf16_f32 v54, v116, v117
  v_cvt_pk_bf16_f32 v55, v118, v119
  v_mfma_f32_16x16x32_bf16 v[120:123], a[144:147], v[232:235], v[120:123]
  ds_read_b128 v[228:231], v15 offset:46080
  v_mfma_f32_16x16x32_bf16 v[124:127], a[148:151], v[232:235], v[124:127]
  buffer_load_dwordx4 v15, s[40:43], s46 offen offset:2048 sc1 lds
  v_mfma_f32_16x16x32_bf16 v[128:131], a[144:147], v[236:239], v[128:131]
  ds_read_b128 v[232:235], v15 offset:43008
  v_mfma_f32_16x16x32_bf16 v[132:135], a[148:151], v[236:239], v[132:135]
  s_waitcnt lgkmcnt(5)
  v_mfma_f32_16x16x32_bf16 v[120:123], a[152:155], v[240:243], v[120:123]
  buffer_load_dwordx4 v15, s[40:43], s46 offen offset:3072 sc1 lds
  ds_read_b128 v[236:239], v15 offset:47104
  v_mfma_f32_16x16x32_bf16 v[124:127], a[156:159], v[240:243], v[124:127]
  v_mfma_f32_16x16x32_bf16 v[128:131], a[152:155], v[244:247], v[128:131]
  ds_read_b128 v[240:243], v15 offset:44032
  v_mfma_f32_16x16x32_bf16 v[132:135], a[156:159], v[244:247], v[132:135]
  s_waitcnt lgkmcnt(5)
  s_add_u32 m0, m0, 4096
  s_nop 0
  v_mfma_f32_16x16x32_bf16 v[120:123], a[160:163], v[216:219], v[120:123]
  buffer_load_dwordx4 v15, s[40:43], s47 offen offset:0 sc1 lds
  ds_read_b128 v[244:247], v15 offset:48128
  v_mfma_f32_16x16x32_bf16 v[124:127], a[164:167], v[216:219], v[124:127]
  v_mfma_f32_16x16x32_bf16 v[128:131], a[160:163], v[220:223], v[128:131]
  ds_read_b128 v[216:219], v15 offset:49152
  v_mfma_f32_16x16x32_bf16 v[132:135], a[164:167], v[220:223], v[132:135]
  s_waitcnt lgkmcnt(5)
  buffer_load_dwordx4 v15, s[40:43], s47 offen offset:1024 sc1 lds
  v_mfma_f32_16x16x32_bf16 v[120:123], a[168:171], v[224:227], v[120:123]
  ds_read_b128 v[220:223], v15 offset:53248
  v_mfma_f32_16x16x32_bf16 v[124:127], a[172:175], v[224:227], v[124:127]
  v_mfma_f32_16x16x32_bf16 v[128:131], a[168:171], v[228:231], v[128:131]
  buffer_load_dwordx4 v15, s[40:43], s47 offen offset:2048 sc1 lds
  ds_read_b128 v[224:227], v15 offset:50176
  v_mfma_f32_16x16x32_bf16 v[132:135], a[172:175], v[228:231], v[132:135]
  s_waitcnt lgkmcnt(5)
  v_mfma_f32_16x16x32_bf16 v[120:123], a[176:179], v[232:235], v[120:123]
  ds_read_b128 v[228:231], v15 offset:54272
  v_mfma_f32_16x16x32_bf16 v[124:127], a[180:183], v[232:235], v[124:127]
  buffer_load_dwordx4 v15, s[40:43], s47 offen offset:3072 sc1 lds
  v_mfma_f32_16x16x32_bf16 v[128:131], a[176:179], v[236:239], v[128:131]
  ds_read_b128 v[232:235], v15 offset:51200
  v_mfma_f32_16x16x32_bf16 v[132:135], a[180:183], v[236:239], v[132:135]
  s_waitcnt lgkmcnt(5)
  v_mfma_f32_16x16x32_bf16 v[120:123], a[184:187], v[240:243], v[120:123]
  s_add_u32 s3, s55, 1
  s_and_b32 s3, s3, 3
  ds_read_b128 v[236:239], v15 offset:55296
  v_mfma_f32_16x16x32_bf16 v[124:127], a[188:191], v[240:243], v[124:127]
  s_lshl_b32 s3, s3, 16
  s_add_u32 s80, s3, s6
  v_mfma_f32_16x16x32_bf16 v[128:131], a[184:187], v[244:247], v[128:131]
  buffer_store_dwordx4 v[48:51], v15, s[24:27], s80 offen offset:0 sc1
  ds_read_b128 v[240:243], v15 offset:52224
  v_mfma_f32_16x16x32_bf16 v[132:135], a[188:191], v[244:247], v[132:135]
  s_waitcnt lgkmcnt(5)
  v_mfma_f32_16x16x32_bf16 v[120:123], a[192:195], v[216:219], v[120:123]
  buffer_store_dwordx4 v[52:55], v15, s[24:27], s80 offen offset:1024 sc1
  ds_read_b128 v[244:247], v15 offset:56320
  v_mfma_f32_16x16x32_bf16 v[124:127], a[196:199], v[216:219], v[124:127]
  v_mfma_f32_16x16x32_bf16 v[128:131], a[192:195], v[220:223], v[128:131]
  ds_read_b128 v[216:219], v15 offset:57344
  v_mfma_f32_16x16x32_bf16 v[132:135], a[196:199], v[220:223], v[132:135]
  s_waitcnt lgkmcnt(5)
  v_mfma_f32_16x16x32_bf16 v[120:123], a[200:203], v[224:227], v[120:123]
  ds_read_b128 v[220:223], v15 offset:61440
  v_mfma_f32_16x16x32_bf16 v[124:127], a[204:207], v[224:227], v[124:127]
  v_mfma_f32_16x16x32_bf16 v[128:131], a[200:203], v[228:231], v[128:131]
  ds_read_b128 v[224:227], v15 offset:58368
  v_mfma_f32_16x16x32_bf16 v[132:135], a[204:207], v[228:231], v[132:135]
  s_waitcnt lgkmcnt(5)
  v_mfma_f32_16x16x32_bf16 v[120:123], a[208:211], v[232:235], v[120:123]
  ds_read_b128 v[228:231], v15 offset:62464
  v_mfma_f32_16x16x32_bf16 v[124:127], a[212:215], v[232:235], v[124:127]
  v_mfma_f32_16x16x32_bf16 v[128:131], a[208:211], v[236:239], v[128:131]
  ds_read_b128 v[232:235], v15 offset:59392
  v_mfma_f32_16x16x32_bf16 v[132:135], a[212:215], v[236:239], v[132:135]
  s_waitcnt lgkmcnt(5)
  v_mfma_f32_16x16x32_bf16 v[120:123], a[216:219], v[240:243], v[120:123]
  ds_read_b128 v[236:239], v15 offset:63488
  v_mfma_f32_16x16x32_bf16 v[124:127], a[220:223], v[240:243], v[124:127]
  v_mfma_f32_16x16x32_bf16 v[128:131], a[216:219], v[244:247], v[128:131]
  ds_read_b128 v[240:243], v15 offset:60416
  v_mfma_f32_16x16x32_bf16 v[132:135], a[220:223], v[244:247], v[132:135]
  s_waitcnt lgkmcnt(5)
  v_mfma_f32_16x16x32_bf16 v[120:123], a[224:227], v[216:219], v[120:123]
  ds_read_b128 v[244:247], v15 offset:64512
  v_mfma_f32_16x16x32_bf16 v[124:127], a[228:231], v[216:219], v[124:127]
  v_mfma_f32_16x16x32_bf16 v[128:131], a[224:227], v[220:223], v[128:131]
  s_waitcnt vmcnt(10)
  s_barrier
  ds_read_b128 v[216:219], v15 offset:0
  v_mfma_f32_16x16x32_bf16 v[132:135], a[228:231], v[220:223], v[132:135]
  s_waitcnt lgkmcnt(5)
  v_mfma_f32_16x16x32_bf16 v[120:123], a[232:235], v[224:227], v[120:123]
  ds_read_b128 v[220:223], v15 offset:4096
  v_mfma_f32_16x16x32_bf16 v[124:127], a[236:239], v[224:227], v[124:127]
  v_mfma_f32_16x16x32_bf16 v[128:131], a[232:235], v[228:231], v[128:131]
  ds_read_b128 v[224:227], v15 offset:1024
  v_mfma_f32_16x16x32_bf16 v[132:135], a[236:239], v[228:231], v[132:135]
  s_waitcnt lgkmcnt(5)
  v_mfma_f32_16x16x32_bf16 v[120:123], a[240:243], v[232:235], v[120:123]
  ds_read_b128 v[228:231], v15 offset:5120
  v_mfma_f32_16x16x32_bf16 v[124:127], a[244:247], v[232:235], v[124:127]
  v_mfma_f32_16x16x32_bf16 v[128:131], a[240:243], v[236:239], v[128:131]
  ds_read_b128 v[232:235], v15 offset:2048
  v_mfma_f32_16x16x32_bf16 v[132:135], a[244:247], v[236:239], v[132:135]
  s_waitcnt lgkmcnt(5)
  v_mfma_f32_16x16x32_bf16 v[120:123], a[248:251], v[240:243], v[120:123]
  ds_read_b128 v[236:239], v15 offset:6144
  v_mfma_f32_16x16x32_bf16 v[124:127], a[252:255], v[240:243], v[124:127]
  v_mfma_f32_16x16x32_bf16 v[128:131], a[248:251], v[244:247], v[128:131]
  ds_read_b128 v[240:243], v15 offset:3072
  v_mfma_f32_16x16x32_bf16 v[132:135], a[252:255], v[244:247], v[132:135]
  s_waitcnt lgkmcnt(5)
  v_mfma_f32_16x16x32_bf16 v[136:139], a[128:131], v[216:219], v[136:139]
  s_add_u32 s3, s55, 0
  s_and_b32 s3, s3, 3
  ds_read_b128 v[244:247], v15 offset:7168
  v_mfma_f32_16x16x32_bf16 v[140:143], a[132:135], v[216:219], v[140:143]
  s_lshl_b32 s3, s3, 18
  s_add_u32 s46, s3, s37
  v_mfma_f32_16x16x32_bf16 v[144:147], a[128:131], v[220:223], v[144:147]
  s_add_u32 m0, s5, 98304
  s_add_u32 s47, s46, 4096
  ds_read_b128 v[216:219], v15 offset:8192
  v_mfma_f32_16x16x32_bf16 v[148:151], a[132:135], v[220:223], v[148:151]
  s_waitcnt lgkmcnt(5)
  buffer_load_dwordx4 v15, s[8:11], s46 offen offset:0 sc1 lds
  v_mfma_f32_16x16x32_bf16 v[136:139], a[136:139], v[224:227], v[136:139]
  ds_read_b128 v[220:223], v15 offset:12288
  v_cvt_pk_bf16_f32 v56, v120, v121
  v_cvt_pk_bf16_f32 v57, v122, v123
  v_mfma_f32_16x16x32_bf16 v[140:143], a[140:143], v[224:227], v[140:143]
  v_cvt_pk_bf16_f32 v58, v124, v125
  v_cvt_pk_bf16_f32 v59, v126, v127
  v_mfma_f32_16x16x32_bf16 v[144:147], a[136:139], v[228:231], v[144:147]
  buffer_load_dwordx4 v15, s[8:11], s46 offen offset:1024 sc1 lds
  ds_read_b128 v[224:227], v15 offset:9216
  v_cvt_pk_bf16_f32 v60, v128, v129
  v_cvt_pk_bf16_f32 v61, v130, v131
  v_mfma_f32_16x16x32_bf16 v[148:151], a[140:143], v[228:231], v[148:151]
  s_waitcnt lgkmcnt(5)
  v_cvt_pk_bf16_f32 v62, v132, v133
  v_cvt_pk_bf16_f32 v63, v134, v135
  v_mfma_f32_16x16x32_bf16 v[136:139], a[144:147], v[232:235], v[136:139]
  ds_read_b128 v[228:231], v15 offset:13312
  v_mfma_f32_16x16x32_bf16 v[140:143], a[148:151], v[232:235], v[140:143]
  buffer_load_dwordx4 v15, s[8:11], s46 offen offset:2048 sc1 lds
  v_mfma_f32_16x16x32_bf16 v[144:147], a[144:147], v[236:239], v[144:147]
  ds_read_b128 v[232:235], v15 offset:10240
  v_mfma_f32_16x16x32_bf16 v[148:151], a[148:151], v[236:239], v[148:151]
  s_waitcnt lgkmcnt(5)
  v_mfma_f32_16x16x32_bf16 v[136:139], a[152:155], v[240:243], v[136:139]
  buffer_load_dwordx4 v15, s[8:11], s46 offen offset:3072 sc1 lds
  ds_read_b128 v[236:239], v15 offset:14336
  v_mfma_f32_16x16x32_bf16 v[140:143], a[156:159], v[240:243], v[140:143]
  v_mfma_f32_16x16x32_bf16 v[144:147], a[152:155], v[244:247], v[144:147]
  ds_read_b128 v[240:243], v15 offset:11264
  v_mfma_f32_16x16x32_bf16 v[148:151], a[156:159], v[244:247], v[148:151]
  s_waitcnt lgkmcnt(5)
  s_add_u32 m0, m0, 4096
  s_nop 0
  v_mfma_f32_16x16x32_bf16 v[136:139], a[160:163], v[216:219], v[136:139]
  buffer_load_dwordx4 v15, s[8:11], s47 offen offset:0 sc1 lds
  ds_read_b128 v[244:247], v15 offset:15360
  v_mfma_f32_16x16x32_bf16 v[140:143], a[164:167], v[216:219], v[140:143]
  v_mfma_f32_16x16x32_bf16 v[144:147], a[160:163], v[220:223], v[144:147]
  ds_read_b128 v[216:219], v15 offset:16384
  v_mfma_f32_16x16x32_bf16 v[148:151], a[164:167], v[220:223], v[148:151]
  s_waitcnt lgkmcnt(5)
  buffer_load_dwordx4 v15, s[8:11], s47 offen offset:1024 sc1 lds
  v_mfma_f32_16x16x32_bf16 v[136:139], a[168:171], v[224:227], v[136:139]
  ds_read_b128 v[220:223], v15 offset:20480
  v_mfma_f32_16x16x32_bf16 v[140:143], a[172:175], v[224:227], v[140:143]
  v_mfma_f32_16x16x32_bf16 v[144:147], a[168:171], v[228:231], v[144:147]
  buffer_load_dwordx4 v15, s[8:11], s47 offen offset:2048 sc1 lds
  ds_read_b128 v[224:227], v15 offset:17408
  v_mfma_f32_16x16x32_bf16 v[148:151], a[172:175], v[228:231], v[148:151]
  s_waitcnt lgkmcnt(5)
  v_mfma_f32_16x16x32_bf16 v[136:139], a[176:179], v[232:235], v[136:139]
  ds_read_b128 v[228:231], v15 offset:21504
  v_mfma_f32_16x16x32_bf16 v[140:143], a[180:183], v[232:235], v[140:143]
  buffer_load_dwordx4 v15, s[8:11], s47 offen offset:3072 sc1 lds
  v_mfma_f32_16x16x32_bf16 v[144:147], a[176:179], v[236:239], v[144:147]
  ds_read_b128 v[232:235], v15 offset:18432
  v_mfma_f32_16x16x32_bf16 v[148:151], a[180:183], v[236:239], v[148:151]
  s_waitcnt lgkmcnt(5)
  v_mfma_f32_16x16x32_bf16 v[136:139], a[184:187], v[240:243], v[136:139]
  s_add_u32 s3, s55, 2
  s_and_b32 s3, s3, 3
  ds_read_b128 v[236:239], v15 offset:22528
  v_mfma_f32_16x16x32_bf16 v[140:143], a[188:191], v[240:243], v[140:143]
  s_lshl_b32 s3, s3, 16
  s_add_u32 s80, s3, s6
  v_mfma_f32_16x16x32_bf16 v[144:147], a[184:187], v[244:247], v[144:147]
  buffer_store_dwordx4 v[56:59], v15, s[24:27], s80 offen offset:0 sc1
  ds_read_b128 v[240:243], v15 offset:19456
  v_mfma_f32_16x16x32_bf16 v[148:151], a[188:191], v[244:247], v[148:151]
  s_waitcnt lgkmcnt(5)
  v_mfma_f32_16x16x32_bf16 v[136:139], a[192:195], v[216:219], v[136:139]
  buffer_store_dwordx4 v[60:63], v15, s[24:27], s80 offen offset:1024 sc1
  ds_read_b128 v[244:247], v15 offset:23552
  v_mfma_f32_16x16x32_bf16 v[140:143], a[196:199], v[216:219], v[140:143]
  v_mfma_f32_16x16x32_bf16 v[144:147], a[192:195], v[220:223], v[144:147]
  ds_read_b128 v[216:219], v15 offset:24576
  v_mfma_f32_16x16x32_bf16 v[148:151], a[196:199], v[220:223], v[148:151]
  s_waitcnt lgkmcnt(5)
  v_mfma_f32_16x16x32_bf16 v[136:139], a[200:203], v[224:227], v[136:139]
  ds_read_b128 v[220:223], v15 offset:28672
  v_mfma_f32_16x16x32_bf16 v[140:143], a[204:207], v[224:227], v[140:143]
  v_mfma_f32_16x16x32_bf16 v[144:147], a[200:203], v[228:231], v[144:147]
  ds_read_b128 v[224:227], v15 offset:25600
  v_mfma_f32_16x16x32_bf16 v[148:151], a[204:207], v[228:231], v[148:151]
  s_waitcnt lgkmcnt(5)
  v_mfma_f32_16x16x32_bf16 v[136:139], a[208:211], v[232:235], v[136:139]
  ds_read_b128 v[228:231], v15 offset:29696
  v_mfma_f32_16x16x32_bf16 v[140:143], a[212:215], v[232:235], v[140:143]
  v_mfma_f32_16x16x32_bf16 v[144:147], a[208:211], v[236:239], v[144:147]
  ds_read_b128 v[232:235], v15 offset:26624
  v_mfma_f32_16x16x32_bf16 v[148:151], a[212:215], v[236:239], v[148:151]
  s_waitcnt lgkmcnt(5)
  v_mfma_f32_16x16x32_bf16 v[136:139], a[216:219], v[240:243], v[136:139]
  ds_read_b128 v[236:239], v15 offset:30720
  v_mfma_f32_16x16x32_bf16 v[140:143], a[220:223], v[240:243], v[140:143]
  v_mfma_f32_16x16x32_bf16 v[144:147], a[216:219], v[244:247], v[144:147]
  ds_read_b128 v[240:243], v15 offset:27648
  v_mfma_f32_16x16x32_bf16 v[148:151], a[220:223], v[244:247], v[148:151]
  s_waitcnt lgkmcnt(5)
  v_mfma_f32_16x16x32_bf16 v[136:139], a[224:227], v[216:219], v[136:139]
  ds_read_b128 v[244:247], v15 offset:31744
  v_mfma_f32_16x16x32_bf16 v[140:143], a[228:231], v[216:219], v[140:143]
  v_mfma_f32_16x16x32_bf16 v[144:147], a[224:227], v[220:223], v[144:147]
  s_waitcnt vmcnt(12)
  s_barrier
  ds_read_b128 v[216:219], v20 offset:0
  v_mfma_f32_16x16x32_bf16 v[148:151], a[228:231], v[220:223], v[148:151]
  s_waitcnt lgkmcnt(5)
  v_mfma_f32_16x16x32_bf16 v[136:139], a[232:235], v[224:227], v[136:139]
  ds_read_b128 v[220:223], v20 offset:4096
  v_mfma_f32_16x16x32_bf16 v[140:143], a[236:239], v[224:227], v[140:143]
  v_mfma_f32_16x16x32_bf16 v[144:147], a[232:235], v[228:231], v[144:147]
  ds_read_b128 v[224:227], v20 offset:1024
  v_mfma_f32_16x16x32_bf16 v[148:151], a[236:239], v[228:231], v[148:151]
  s_waitcnt lgkmcnt(5)
  v_mfma_f32_16x16x32_bf16 v[136:139], a[240:243], v[232:235], v[136:139]
  ds_read_b128 v[228:231], v20 offset:5120
  v_mfma_f32_16x16x32_bf16 v[140:143], a[244:247], v[232:235], v[140:143]
  v_mfma_f32_16x16x32_bf16 v[144:147], a[240:243], v[236:239], v[144:147]
  ds_read_b128 v[232:235], v20 offset:2048
  v_mfma_f32_16x16x32_bf16 v[148:151], a[244:247], v[236:239], v[148:151]
  s_waitcnt lgkmcnt(5)
  v_mfma_f32_16x16x32_bf16 v[136:139], a[248:251], v[240:243], v[136:139]
  ds_read_b128 v[236:239], v20 offset:6144
  v_mfma_f32_16x16x32_bf16 v[140:143], a[252:255], v[240:243], v[140:143]
  v_mfma_f32_16x16x32_bf16 v[144:147], a[248:251], v[244:247], v[144:147]
  ds_read_b128 v[240:243], v20 offset:3072
  v_mfma_f32_16x16x32_bf16 v[148:151], a[252:255], v[244:247], v[148:151]
  s_waitcnt lgkmcnt(5)
  v_mfma_f32_16x16x32_bf16 v[88:91], a[32:35], v[216:219], v[88:91]
  ds_read_b128 v[244:247], v20 offset:7168
  v_mfma_f32_16x16x32_bf16 v[92:95], a[36:39], v[216:219], v[92:95]
  v_mfma_f32_16x16x32_bf16 v[96:99], a[32:35], v[220:223], v[96:99]
  ds_read_b128 v[216:219], v20 offset:8192
  v_mfma_f32_16x16x32_bf16 v[100:103], a[36:39], v[220:223], v[100:103]
  s_waitcnt lgkmcnt(5)
  v_mfma_f32_16x16x32_bf16 v[88:91], a[40:43], v[224:227], v[88:91]
  ds_read_b128 v[220:223], v20 offset:12288
  v_cvt_pk_bf16_f32 v64, v136, v137
  v_cvt_pk_bf16_f32 v65, v138, v139
  v_mfma_f32_16x16x32_bf16 v[92:95], a[44:47], v[224:227], v[92:95]
  s_add_u32 s3, s55, 3
  s_and_b32 s3, s3, 3
  v_cvt_pk_bf16_f32 v66, v140, v141
  v_cvt_pk_bf16_f32 v67, v142, v143
  v_mfma_f32_16x16x32_bf16 v[96:99], a[40:43], v[228:231], v[96:99]
  s_lshl_b32 s3, s3, 16
  s_add_u32 s80, s3, s6
  ds_read_b128 v[224:227], v20 offset:9216
  v_cvt_pk_bf16_f32 v68, v144, v145
  v_cvt_pk_bf16_f32 v69, v146, v147
  v_mfma_f32_16x16x32_bf16 v[100:103], a[44:47], v[228:231], v[100:103]
  s_waitcnt lgkmcnt(5)
  buffer_store_dwordx4 v[64:67], v15, s[24:27], s80 offen offset:0 sc1
  v_cvt_pk_bf16_f32 v70, v148, v149
  v_cvt_pk_bf16_f32 v71, v150, v151
  v_mfma_f32_16x16x32_bf16 v[88:91], a[48:51], v[232:235], v[88:91]
  ds_read_b128 v[228:231], v20 offset:13312
  v_mfma_f32_16x16x32_bf16 v[92:95], a[52:55], v[232:235], v[92:95]
  buffer_store_dwordx4 v[68:71], v15, s[24:27], s80 offen offset:1024 sc1
  v_mfma_f32_16x16x32_bf16 v[96:99], a[48:51], v[236:239], v[96:99]
  ds_read_b128 v[232:235], v20 offset:10240
  v_mfma_f32_16x16x32_bf16 v[100:103], a[52:55], v[236:239], v[100:103]
  s_waitcnt lgkmcnt(5)
  v_mfma_f32_16x16x32_bf16 v[88:91], a[56:59], v[240:243], v[88:91]
  ds_read_b128 v[236:239], v20 offset:14336
  v_mfma_f32_16x16x32_bf16 v[92:95], a[60:63], v[240:243], v[92:95]
  v_mfma_f32_16x16x32_bf16 v[96:99], a[56:59], v[244:247], v[96:99]
  ds_read_b128 v[240:243], v20 offset:11264
  v_mfma_f32_16x16x32_bf16 v[100:103], a[60:63], v[244:247], v[100:103]
  s_waitcnt lgkmcnt(5)
  v_mfma_f32_16x16x32_bf16 v[88:91], a[64:67], v[216:219], v[88:91]
  ds_read_b128 v[244:247], v20 offset:15360
  v_mfma_f32_16x16x32_bf16 v[92:95], a[68:71], v[216:219], v[92:95]
  v_mfma_f32_16x16x32_bf16 v[96:99], a[64:67], v[220:223], v[96:99]
  ds_read_b128 v[216:219], v20 offset:16384
  v_mfma_f32_16x16x32_bf16 v[100:103], a[68:71], v[220:223], v[100:103]
  s_waitcnt lgkmcnt(5)
  v_mfma_f32_16x16x32_bf16 v[88:91], a[72:75], v[224:227], v[88:91]
  ds_read_b128 v[220:223], v20 offset:20480
  v_mfma_f32_16x16x32_bf16 v[92:95], a[76:79], v[224:227], v[92:95]
  v_mfma_f32_16x16x32_bf16 v[96:99], a[72:75], v[228:231], v[96:99]
  ds_read_b128 v[224:227], v20 offset:17408
  v_mfma_f32_16x16x32_bf16 v[100:103], a[76:79], v[228:231], v[100:103]
  s_waitcnt lgkmcnt(5)
  v_mfma_f32_16x16x32_bf16 v[88:91], a[80:83], v[232:235], v[88:91]
  ds_read_b128 v[228:231], v20 offset:21504
  v_mfma_f32_16x16x32_bf16 v[92:95], a[84:87], v[232:235], v[92:95]
  v_mfma_f32_16x16x32_bf16 v[96:99], a[80:83], v[236:239], v[96:99]
  ds_read_b128 v[232:235], v20 offset:18432
  v_mfma_f32_16x16x32_bf16 v[100:103], a[84:87], v[236:239], v[100:103]
  s_waitcnt lgkmcnt(5)
  v_mfma_f32_16x16x32_bf16 v[88:91], a[88:91], v[240:243], v[88:91]
  ds_read_b128 v[236:239], v20 offset:22528
  v_mfma_f32_16x16x32_bf16 v[92:95], a[92:95], v[240:243], v[92:95]
  v_mfma_f32_16x16x32_bf16 v[96:99], a[88:91], v[244:247], v[96:99]
  ds_read_b128 v[240:243], v20 offset:19456
  v_mfma_f32_16x16x32_bf16 v[100:103], a[92:95], v[244:247], v[100:103]
  s_waitcnt lgkmcnt(5)
  v_mfma_f32_16x16x32_bf16 v[88:91], a[96:99], v[216:219], v[88:91]
  ds_read_b128 v[244:247], v20 offset:23552
L_sig2:
  s_waitcnt vmcnt(0)
  v_mov_b32 v38, 1
  s_mov_b64 exec, 1
  buffer_store_dword v38, v37, s[24:27], s75 offen sc1
  s_mov_b64 exec, s[78:79]
  v_mfma_f32_16x16x32_bf16 v[92:95], a[100:103], v[216:219], v[92:95]
  v_mfma_f32_16x16x32_bf16 v[96:99], a[96:99], v[220:223], v[96:99]
  s_waitcnt vmcnt(4)
  s_barrier
  ds_read_b128 v[216:219], v20 offset:32768
  v_mfma_f32_16x16x32_bf16 v[100:103], a[100:103], v[220:223], v[100:103]
  s_waitcnt lgkmcnt(5)
  v_mfma_f32_16x16x32_bf16 v[88:91], a[104:107], v[224:227], v[88:91]
  ds_read_b128 v[220:223], v20 offset:36864
  v_mfma_f32_16x16x32_bf16 v[92:95], a[108:111], v[224:227], v[92:95]
  v_mfma_f32_16x16x32_bf16 v[96:99], a[104:107], v[228:231], v[96:99]
  ds_read_b128 v[224:227], v20 offset:33792
  v_mfma_f32_16x16x32_bf16 v[100:103], a[108:111], v[228:231], v[100:103]
  s_waitcnt lgkmcnt(5)
  v_mfma_f32_16x16x32_bf16 v[88:91], a[112:115], v[232:235], v[88:91]
  ds_read_b128 v[228:231], v20 offset:37888
  v_mfma_f32_16x16x32_bf16 v[92:95], a[116:119], v[232:235], v[92:95]
  v_mfma_f32_16x16x32_bf16 v[96:99], a[112:115], v[236:239], v[96:99]
  ds_read_b128 v[232:235], v20 offset:34816
  v_mfma_f32_16x16x32_bf16 v[100:103], a[116:119], v[236:239], v[100:103]
  s_waitcnt lgkmcnt(5)
  v_mfma_f32_16x16x32_bf16 v[88:91], a[120:123], v[240:243], v[88:91]
  ds_read_b128 v[236:239], v20 offset:38912
  v_mfma_f32_16x16x32_bf16 v[92:95], a[124:127], v[240:243], v[92:95]
  v_mfma_f32_16x16x32_bf16 v[96:99], a[120:123], v[244:247], v[96:99]
  ds_read_b128 v[240:243], v20 offset:35840
  v_mfma_f32_16x16x32_bf16 v[100:103], a[124:127], v[244:247], v[100:103]
  s_waitcnt lgkmcnt(5)
  v_mfma_f32_16x16x32_bf16 v[88:91], a[128:131], v[216:219], v[88:91]
  ds_read_b128 v[244:247], v20 offset:39936
  v_mfma_f32_16x16x32_bf16 v[92:95], a[132:135], v[216:219], v[92:95]
  v_mfma_f32_16x16x32_bf16 v[96:99], a[128:131], v[220:223], v[96:99]
  ds_read_b128 v[216:219], v20 offset:40960
  v_mfma_f32_16x16x32_bf16 v[100:103], a[132:135], v[220:223], v[100:103]
  s_waitcnt lgkmcnt(5)
  v_mfma_f32_16x16x32_bf16 v[88:91], a[136:139], v[224:227], v[88:91]
  ds_read_b128 v[220:223], v20 offset:45056
  v_mfma_f32_16x16x32_bf16 v[92:95], a[140:143], v[224:227], v[92:95]
  v_mfma_f32_16x16x32_bf16 v[96:99], a[136:139], v[228:231], v[96:99]
  ds_read_b128 v[224:227], v20 offset:41984
  v_mfma_f32_16x16x32_bf16 v[100:103], a[140:143], v[228:231], v[100:103]
  s_waitcnt lgkmcnt(5)
  v_mfma_f32_16x16x32_bf16 v[88:91], a[144:147], v[232:235], v[88:91]
  ds_read_b128 v[228:231], v20 offset:46080
  v_mfma_f32_16x16x32_bf16 v[92:95], a[148:151], v[232:235], v[92:95]
  v_mfma_f32_16x16x32_bf16 v[96:99], a[144:147], v[236:239], v[96:99]
  ds_read_b128 v[232:235], v20 offset:43008
  v_mfma_f32_16x16x32_bf16 v[100:103], a[148:151], v[236:239], v[100:103]
  s_waitcnt lgkmcnt(5)
  v_mfma_f32_16x16x32_bf16 v[88:91], a[152:155], v[240:243], v[88:91]
  s_lshl_b32 s4, s55, 16
  s_add_u32 s4, s4, s81
  ds_read_b128 v[236:239], v20 offset:47104
  v_mfma_f32_16x16x32_bf16 v[92:95], a[156:159], v[240:243], v[92:95]
  s_add_u32 s3, s55, 1
  s_and_b32 s3, s3, 3
  v_mfma_f32_16x16x32_bf16 v[96:99], a[152:155], v[244:247], v[96:99]
  s_lshl_b32 s3, s3, 14
  s_add_u32 s36, s3, s4
  ds_read_b128 v[240:243], v20 offset:44032
  v_mfma_f32_16x16x32_bf16 v[100:103], a[156:159], v[244:247], v[100:103]
  s_waitcnt lgkmcnt(5)
  s_add_u32 s3, s55, 2
  s_and_b32 s3, s3, 3
  v_mfma_f32_16x16x32_bf16 v[88:91], a[160:163], v[216:219], v[88:91]
  s_lshl_b32 s3, s3, 14
  s_add_u32 s37, s3, s4
  ds_read_b128 v[244:247], v20 offset:48128
  v_mfma_f32_16x16x32_bf16 v[92:95], a[164:167], v[216:219], v[92:95]
  s_add_u32 s3, s55, 3
  s_and_b32 s3, s3, 3
  v_mfma_f32_16x16x32_bf16 v[96:99], a[160:163], v[220:223], v[96:99]
  s_lshl_b32 s3, s3, 14
  s_add_u32 s38, s3, s4
  ds_read_b128 v[216:219], v20 offset:49152
  v_mfma_f32_16x16x32_bf16 v[100:103], a[164:167], v[220:223], v[100:103]
  s_waitcnt lgkmcnt(5)
  v_and_b32 v2, 15, v1
  v_lshrrev_b32 v5, 4, v1
  v_mfma_f32_16x16x32_bf16 v[88:91], a[168:171], v[224:227], v[88:91]
  ds_read_b128 v[220:223], v20 offset:53248
  v_lshlrev_b32 v2, 11, v2
  v_lshl_add_u32 v2, v5, 4, v2
  v_mfma_f32_16x16x32_bf16 v[92:95], a[172:175], v[224:227], v[92:95]
  s_lshl_b32 s3, s35, 18
  s_lshl_b32 s4, s55, 16
  v_mfma_f32_16x16x32_bf16 v[96:99], a[168:171], v[228:231], v[96:99]
  s_add_u32 s7, s3, s4
  s_cmp_lt_u32 s29, 2
  ds_read_b128 v[224:227], v20 offset:50176
  v_mfma_f32_16x16x32_bf16 v[100:103], a[172:175], v[228:231], v[100:103]
  s_waitcnt lgkmcnt(5)
  s_cselect_b32 s4, s44, s45
  s_add_u32 s7, s7, s4
  v_mfma_f32_16x16x32_bf16 v[88:91], a[176:179], v[232:235], v[88:91]
  s_lshl_b32 s4, s29, 6
  s_add_u32 s7, s7, s4
  ds_read_b128 v[228:231], v20 offset:54272
  v_mfma_f32_16x16x32_bf16 v[92:95], a[180:183], v[232:235], v[92:95]
  s_add_u32 s39, s7, 0x8000
  v_mfma_f32_16x16x32_bf16 v[96:99], a[176:179], v[236:239], v[96:99]
  ds_read_b128 v[232:235], v20 offset:51200
  v_mfma_f32_16x16x32_bf16 v[100:103], a[180:183], v[236:239], v[100:103]
  s_waitcnt lgkmcnt(5)
  v_mfma_f32_16x16x32_bf16 v[88:91], a[184:187], v[240:243], v[88:91]
  ds_read_b128 v[236:239], v20 offset:55296
L_pq8:
  s_mov_b64 exec, 14
  buffer_load_dword v39, v4, s[24:27], s75 offen sc1
  s_mov_b64 exec, s[78:79]
  v_mfma_f32_16x16x32_bf16 v[92:95], a[188:191], v[240:243], v[92:95]
  v_mfma_f32_16x16x32_bf16 v[96:99], a[184:187], v[244:247], v[96:99]
  ds_read_b128 v[240:243], v20 offset:52224
  v_mfma_f32_16x16x32_bf16 v[100:103], a[188:191], v[244:247], v[100:103]
  s_waitcnt lgkmcnt(5)
  v_mfma_f32_16x16x32_bf16 v[88:91], a[192:195], v[216:219], v[88:91]
  ds_read_b128 v[244:247], v20 offset:56320
  v_mfma_f32_16x16x32_bf16 v[92:95], a[196:199], v[216:219], v[92:95]
  v_mfma_f32_16x16x32_bf16 v[96:99], a[192:195], v[220:223], v[96:99]
  ds_read_b128 v[216:219], v20 offset:57344
  v_mfma_f32_16x16x32_bf16 v[100:103], a[196:199], v[220:223], v[100:103]
  s_waitcnt lgkmcnt(5)
  v_mfma_f32_16x16x32_bf16 v[88:91], a[200:203], v[224:227], v[88:91]
  ds_read_b128 v[220:223], v20 offset:61440
  v_mfma_f32_16x16x32_bf16 v[92:95], a[204:207], v[224:227], v[92:95]
  v_mfma_f32_16x16x32_bf16 v[96:99], a[200:203], v[228:231], v[96:99]
  ds_read_b128 v[224:227], v20 offset:58368
  v_mfma_f32_16x16x32_bf16 v[100:103], a[204:207], v[228:231], v[100:103]
  s_waitcnt lgkmcnt(5)
  v_mfma_f32_16x16x32_bf16 v[88:91], a[208:211], v[232:235], v[88:91]
  ds_read_b128 v[228:231], v20 offset:62464
  v_mfma_f32_16x16x32_bf16 v[92:95], a[212:215], v[232:235], v[92:95]
  v_mfma_f32_16x16x32_bf16 v[96:99], a[208:211], v[236:239], v[96:99]
  ds_read_b128 v[232:235], v20 offset:59392
  v_mfma_f32_16x16x32_bf16 v[100:103], a[212:215], v[236:239], v[100:103]
  s_waitcnt lgkmcnt(5)
  v_mfma_f32_16x16x32_bf16 v[88:91], a[216:219], v[240:243], v[88:91]
  ds_read_b128 v[236:239], v20 offset:63488
  v_mfma_f32_16x16x32_bf16 v[92:95], a[220:223], v[240:243], v[92:95]
  v_mfma_f32_16x16x32_bf16 v[96:99], a[216:219], v[244:247], v[96:99]
  ds_read_b128 v[240:243], v20 offset:60416
  v_mfma_f32_16x16x32_bf16 v[100:103], a[220:223], v[244:247], v[100:103]
  s_waitcnt lgkmcnt(5)
  v_mfma_f32_16x16x32_bf16 v[88:91], a[224:227], v[216:219], v[88:91]
  ds_read_b128 v[244:247], v20 offset:64512
  v_mfma_f32_16x16x32_bf16 v[92:95], a[228:231], v[216:219], v[92:95]
  v_mfma_f32_16x16x32_bf16 v[96:99], a[224:227], v[220:223], v[96:99]
  v_mfma_f32_16x16x32_bf16 v[100:103], a[228:231], v[220:223], v[100:103]
  s_waitcnt lgkmcnt(4)
  v_mfma_f32_16x16x32_bf16 v[88:91], a[232:235], v[224:227], v[88:91]
  v_mfma_f32_16x16x32_bf16 v[92:95], a[236:239], v[224:227], v[92:95]
  v_mfma_f32_16x16x32_bf16 v[96:99], a[232:235], v[228:231], v[96:99]
  v_mfma_f32_16x16x32_bf16 v[100:103], a[236:239], v[228:231], v[100:103]
  s_waitcnt lgkmcnt(2)
  v_mfma_f32_16x16x32_bf16 v[88:91], a[240:243], v[232:235], v[88:91]
L_pt8:
  s_waitcnt vmcnt(0)
  v_cmp_ne_u32 vcc, 1, v39
  s_nop 1
  s_and_b32 s98, vcc_lo, 14
  s_cselect_b32 s42, 0, 0x2000000
  v_mfma_f32_16x16x32_bf16 v[92:95], a[244:247], v[232:235], v[92:95]
  buffer_load_dwordx4 v[200:203], v15, s[40:43], s38 offen offset:0 sc1
  v_mfma_f32_16x16x32_bf16 v[96:99], a[240:243], v[236:239], v[96:99]
  buffer_load_dwordx4 v[204:207], v15, s[40:43], s38 offen offset:1024 sc1
  v_mfma_f32_16x16x32_bf16 v[100:103], a[244:247], v[236:239], v[100:103]
  s_waitcnt lgkmcnt(0)
  buffer_load_dwordx4 v[184:187], v15, s[40:43], s37 offen offset:0 sc1
  v_mfma_f32_16x16x32_bf16 v[88:91], a[248:251], v[240:243], v[88:91]
  buffer_load_dwordx4 v[188:191], v15, s[40:43], s37 offen offset:1024 sc1
  v_mfma_f32_16x16x32_bf16 v[92:95], a[252:255], v[240:243], v[92:95]
  buffer_load_dwordx4 v[168:171], v15, s[40:43], s36 offen offset:0 sc1
  v_mfma_f32_16x16x32_bf16 v[96:99], a[248:251], v[244:247], v[96:99]
  buffer_load_dwordx4 v[172:175], v15, s[40:43], s36 offen offset:1024 sc1
  v_mfma_f32_16x16x32_bf16 v[100:103], a[252:255], v[244:247], v[100:103]
  s_cmp_eq_u32 s98, 0
  s_cbranch_scc1 L_have
  s_mov_b32 s76, 0
L_pb3:
  s_mov_b64 exec, 14
  buffer_load_dword v39, v4, s[24:27], s75 offen sc1
  s_mov_b64 exec, s[78:79]
  s_waitcnt vmcnt(0)
  v_cmp_ne_u32 vcc, 1, v39
  s_nop 1
  s_and_b32 s98, vcc_lo, 14
  s_cbranch_scc0 L_pb3_out
  s_add_u32 s76, s76, 1
  s_cmp_ge_u32 s76, 32768
  s_cbranch_scc1 L_pb3_out
  s_branch L_pb3
L_pb3_out:
  buffer_load_dwordx4 v[200:203], v15, s[24:27], s38 offen offset:0 sc1
  buffer_load_dwordx4 v[204:207], v15, s[24:27], s38 offen offset:1024 sc1
  buffer_load_dwordx4 v[184:187], v15, s[24:27], s37 offen offset:0 sc1
  buffer_load_dwordx4 v[188:191], v15, s[24:27], s37 offen offset:1024 sc1
  buffer_load_dwordx4 v[168:171], v15, s[24:27], s36 offen offset:0 sc1
  buffer_load_dwordx4 v[172:175], v15, s[24:27], s36 offen offset:1024 sc1
L_have:
  s_nop 3
  s_mov_b32 s76, 0
  s_waitcnt vmcnt(4)
  v_and_b32 v208, 0xffff0000, v200
  v_lshlrev_b32 v200, 16, v200
  v_and_b32 v209, 0xffff0000, v201
  v_lshlrev_b32 v201, 16, v201
  v_and_b32 v210, 0xffff0000, v202
  v_lshlrev_b32 v202, 16, v202
  v_and_b32 v211, 0xffff0000, v203
  v_lshlrev_b32 v203, 16, v203
  v_and_b32 v212, 0xffff0000, v204
  v_lshlrev_b32 v204, 16, v204
  v_and_b32 v213, 0xffff0000, v205
  v_lshlrev_b32 v205, 16, v205
  v_and_b32 v214, 0xffff0000, v206
  v_lshlrev_b32 v206, 16, v206
  v_and_b32 v215, 0xffff0000, v207
  v_lshlrev_b32 v207, 16, v207
  v_add_f32 v88, v88, v200
  v_add_f32 v89, v89, v208
  v_add_f32 v90, v90, v201
  v_add_f32 v91, v91, v209
  v_add_f32 v92, v92, v202
  v_add_f32 v93, v93, v210
  v_add_f32 v94, v94, v203
  v_add_f32 v95, v95, v211
  v_add_f32 v96, v96, v204
  v_add_f32 v97, v97, v212
  v_add_f32 v98, v98, v205
  v_add_f32 v99, v99, v213
  v_add_f32 v100, v100, v206
  v_add_f32 v101, v101, v214
  v_add_f32 v102, v102, v207
  v_add_f32 v103, v103, v215
  s_waitcnt vmcnt(2)
  v_and_b32 v192, 0xffff0000, v184
  v_lshlrev_b32 v184, 16, v184
  v_and_b32 v193, 0xffff0000, v185
  v_lshlrev_b32 v185, 16, v185
  v_and_b32 v194, 0xffff0000, v186
  v_lshlrev_b32 v186, 16, v186
  v_and_b32 v195, 0xffff0000, v187
  v_lshlrev_b32 v187, 16, v187
  v_and_b32 v196, 0xffff0000, v188
  v_lshlrev_b32 v188, 16, v188
  v_and_b32 v197, 0xffff0000, v189
  v_lshlrev_b32 v189, 16, v189
  v_and_b32 v198, 0xffff0000, v190
  v_lshlrev_b32 v190, 16, v190
  v_and_b32 v199, 0xffff0000, v191
  v_lshlrev_b32 v191, 16, v191
  v_add_f32 v88, v88, v184
  v_add_f32 v89, v89, v192
  v_add_f32 v90, v90, v185
  v_add_f32 v91, v91, v193
  v_add_f32 v92, v92, v186
  v_add_f32 v93, v93, v194
  v_add_f32 v94, v94, v187
  v_add_f32 v95, v95, v195
  v_add_f32 v96, v96, v188
  v_add_f32 v97, v97, v196
  v_add_f32 v98, v98, v189
  v_add_f32 v99, v99, v197
  v_add_f32 v100, v100, v190
  v_add_f32 v101, v101, v198
  v_add_f32 v102, v102, v191
  v_add_f32 v103, v103, v199
  s_waitcnt vmcnt(0)
  v_and_b32 v176, 0xffff0000, v168
  v_lshlrev_b32 v168, 16, v168
  v_and_b32 v177, 0xffff0000, v169
  v_lshlrev_b32 v169, 16, v169
  v_and_b32 v178, 0xffff0000, v170
  v_lshlrev_b32 v170, 16, v170
  v_and_b32 v179, 0xffff0000, v171
  v_lshlrev_b32 v171, 16, v171
  v_and_b32 v180, 0xffff0000, v172
  v_lshlrev_b32 v172, 16, v172
  v_and_b32 v181, 0xffff0000, v173
  v_lshlrev_b32 v173, 16, v173
  v_and_b32 v182, 0xffff0000, v174
  v_lshlrev_b32 v174, 16, v174
  v_and_b32 v183, 0xffff0000, v175
  v_lshlrev_b32 v175, 16, v175
  v_add_f32 v88, v88, v168
  v_add_f32 v89, v89, v176
  v_add_f32 v90, v90, v169
  v_add_f32 v91, v91, v177
  v_add_f32 v92, v92, v170
  v_add_f32 v93, v93, v178
  v_add_f32 v94, v94, v171
  v_add_f32 v95, v95, v179
  v_add_f32 v96, v96, v172
  v_add_f32 v97, v97, v180
  v_add_f32 v98, v98, v173
  v_add_f32 v99, v99, v181
  v_add_f32 v100, v100, v174
  v_add_f32 v101, v101, v182
  v_add_f32 v102, v102, v175
  v_add_f32 v103, v103, v183
  v_cvt_pk_bf16_f32 v40, v88, v89
  v_cvt_pk_bf16_f32 v41, v90, v91
  v_cvt_pk_bf16_f32 v42, v92, v93
  v_cvt_pk_bf16_f32 v43, v94, v95
  v_cvt_pk_bf16_f32 v44, v96, v97
  v_cvt_pk_bf16_f32 v45, v98, v99
  v_cvt_pk_bf16_f32 v46, v100, v101
  v_cvt_pk_bf16_f32 v47, v102, v103
  buffer_store_dwordx4 v[40:43], v2, s[60:63], s7 offen sc1
  buffer_store_dwordx4 v[44:47], v2, s[60:63], s39 offen sc1
L_end:
  s_endpgm
L_rare0:
  s_nop 15
  v_max3_f32 v32, v120, v121, v122
  v_max3_f32 v32, v32, v123, v124
  v_max3_f32 v32, v32, v125, v126
  v_max3_f32 v32, v32, v127, v128
  v_max3_f32 v32, v32, v129, v130
  v_max3_f32 v32, v32, v131, v132
  v_max3_f32 v32, v32, v133, v134
  v_max_f32 v32, v32, v135
  v_mov_b32 v30, v32
  s_nop 1
  v_permlane32_swap_b32 v32, v30
  s_nop 1
  v_max_f32 v32, v32, v30
  v_mov_b32 v30, v32
  s_nop 1
  v_permlane16_swap_b32 v32, v30
  s_nop 1
  v_max_f32 v32, v32, v30
  v_max_f32 v32, 0, v32
  v_sub_f32 v30, 0, v32
  v_exp_f32 v34, v30
  v_sub_f32 v120, v120, v32
  v_sub_f32 v121, v121, v32
  v_sub_f32 v122, v122, v32
  v_sub_f32 v123, v123, v32
  v_sub_f32 v124, v124, v32
  v_sub_f32 v125, v125, v32
  v_sub_f32 v126, v126, v32
  v_sub_f32 v127, v127, v32
  v_sub_f32 v128, v128, v32
  v_sub_f32 v129, v129, v32
  v_sub_f32 v130, v130, v32
  v_sub_f32 v131, v131, v32
  v_sub_f32 v132, v132, v32
  v_sub_f32 v133, v133, v32
  v_sub_f32 v134, v134, v32
  v_sub_f32 v135, v135, v32
  v_sub_f32 v72, v72, v32
  v_sub_f32 v73, v73, v32
  v_sub_f32 v74, v74, v32
  v_sub_f32 v75, v75, v32
  v_mul_f32 v80, v80, v34
  v_mul_f32 v81, v81, v34
  v_mul_f32 v82, v82, v34
  v_mul_f32 v83, v83, v34
  v_mul_f32 v152, v152, v34
  v_mul_f32 v153, v153, v34
  v_mul_f32 v154, v154, v34
  v_mul_f32 v155, v155, v34
  v_mul_f32 v160, v160, v34
  v_mul_f32 v161, v161, v34
  v_mul_f32 v162, v162, v34
  v_mul_f32 v163, v163, v34
  v_mul_f32 v168, v168, v34
  v_mul_f32 v169, v169, v34
  v_mul_f32 v170, v170, v34
  v_mul_f32 v171, v171, v34
  v_mul_f32 v176, v176, v34
  v_mul_f32 v177, v177, v34
  v_mul_f32 v178, v178, v34
  v_mul_f32 v179, v179, v34
  v_mul_f32 v184, v184, v34
  v_mul_f32 v185, v185, v34
  v_mul_f32 v186, v186, v34
  v_mul_f32 v187, v187, v34
  v_mul_f32 v192, v192, v34
  v_mul_f32 v193, v193, v34
  v_mul_f32 v194, v194, v34
  v_mul_f32 v195, v195, v34
  v_mul_f32 v200, v200, v34
  v_mul_f32 v201, v201, v34
  v_mul_f32 v202, v202, v34
  v_mul_f32 v203, v203, v34
  v_mul_f32 v208, v208, v34
  v_mul_f32 v209, v209, v34
  v_mul_f32 v210, v210, v34
  v_mul_f32 v211, v211, v34
  v_max3_f32 v33, v136, v137, v138
  v_max3_f32 v33, v33, v139, v140
  v_max3_f32 v33, v33, v141, v142
  v_max3_f32 v33, v33, v143, v144
  v_max3_f32 v33, v33, v145, v146
  v_max3_f32 v33, v33, v147, v148
  v_max3_f32 v33, v33, v149, v150
  v_max_f32 v33, v33, v151
  v_mov_b32 v30, v33
  s_nop 1
  v_permlane32_swap_b32 v33, v30
  s_nop 1
  v_max_f32 v33, v33, v30
  v_mov_b32 v30, v33
  s_nop 1
  v_permlane16_swap_b32 v33, v30
  s_nop 1
  v_max_f32 v33, v33, v30
  v_max_f32 v33, 0, v33
  v_sub_f32 v30, 0, v33
  v_exp_f32 v35, v30
  v_sub_f32 v136, v136, v33
  v_sub_f32 v137, v137, v33
  v_sub_f32 v138, v138, v33
  v_sub_f32 v139, v139, v33
  v_sub_f32 v140, v140, v33
  v_sub_f32 v141, v141, v33
  v_sub_f32 v142, v142, v33
  v_sub_f32 v143, v143, v33
  v_sub_f32 v144, v144, v33
  v_sub_f32 v145, v145, v33
  v_sub_f32 v146, v146, v33
  v_sub_f32 v147, v147, v33
  v_sub_f32 v148, v148, v33
  v_sub_f32 v149, v149, v33
  v_sub_f32 v150, v150, v33
  v_sub_f32 v151, v151, v33
  v_sub_f32 v76, v76, v33
  v_sub_f32 v77, v77, v33
  v_sub_f32 v78, v78, v33
  v_sub_f32 v79, v79, v33
  v_mul_f32 v84, v84, v35
  v_mul_f32 v85, v85, v35
  v_mul_f32 v86, v86, v35
  v_mul_f32 v87, v87, v35
  v_mul_f32 v156, v156, v35
  v_mul_f32 v157, v157, v35
  v_mul_f32 v158, v158, v35
  v_mul_f32 v159, v159, v35
  v_mul_f32 v164, v164, v35
  v_mul_f32 v165, v165, v35
  v_mul_f32 v166, v166, v35
  v_mul_f32 v167, v167, v35
  v_mul_f32 v172, v172, v35
  v_mul_f32 v173, v173, v35
  v_mul_f32 v174, v174, v35
  v_mul_f32 v175, v175, v35
  v_mul_f32 v180, v180, v35
  v_mul_f32 v181, v181, v35
  v_mul_f32 v182, v182, v35
  v_mul_f32 v183, v183, v35
  v_mul_f32 v188, v188, v35
  v_mul_f32 v189, v189, v35
  v_mul_f32 v190, v190, v35
  v_mul_f32 v191, v191, v35
  v_mul_f32 v196, v196, v35
  v_mul_f32 v197, v197, v35
  v_mul_f32 v198, v198, v35
  v_mul_f32 v199, v199, v35
  v_mul_f32 v204, v204, v35
  v_mul_f32 v205, v205, v35
  v_mul_f32 v206, v206, v35
  v_mul_f32 v207, v207, v35
  v_mul_f32 v212, v212, v35
  v_mul_f32 v213, v213, v35
  v_mul_f32 v214, v214, v35
  v_mul_f32 v215, v215, v35
  s_nop 3
  s_branch L_rare0_ret
L_rare1:
  s_nop 15
  v_max3_f32 v32, v88, v89, v90
  v_max3_f32 v32, v32, v91, v92
  v_max3_f32 v32, v32, v93, v94
  v_max3_f32 v32, v32, v95, v96
  v_max3_f32 v32, v32, v97, v98
  v_max3_f32 v32, v32, v99, v100
  v_max3_f32 v32, v32, v101, v102
  v_max_f32 v32, v32, v103
  v_mov_b32 v30, v32
  s_nop 1
  v_permlane32_swap_b32 v32, v30
  s_nop 1
  v_max_f32 v32, v32, v30
  v_mov_b32 v30, v32
  s_nop 1
  v_permlane16_swap_b32 v32, v30
  s_nop 1
  v_max_f32 v32, v32, v30
  v_max_f32 v32, 0, v32
  v_sub_f32 v30, 0, v32
  v_exp_f32 v34, v30
  v_sub_f32 v88, v88, v32
  v_sub_f32 v89, v89, v32
  v_sub_f32 v90, v90, v32
  v_sub_f32 v91, v91, v32
  v_sub_f32 v92, v92, v32
  v_sub_f32 v93, v93, v32
  v_sub_f32 v94, v94, v32
  v_sub_f32 v95, v95, v32
  v_sub_f32 v96, v96, v32
  v_sub_f32 v97, v97, v32
  v_sub_f32 v98, v98, v32
  v_sub_f32 v99, v99, v32
  v_sub_f32 v100, v100, v32
  v_sub_f32 v101, v101, v32
  v_sub_f32 v102, v102, v32
  v_sub_f32 v103, v103, v32
  v_sub_f32 v72, v72, v32
  v_sub_f32 v73, v73, v32
  v_sub_f32 v74, v74, v32
  v_sub_f32 v75, v75, v32
  v_mul_f32 v80, v80, v34
  v_mul_f32 v81, v81, v34
  v_mul_f32 v82, v82, v34
  v_mul_f32 v83, v83, v34
  v_mul_f32 v152, v152, v34
  v_mul_f32 v153, v153, v34
  v_mul_f32 v154, v154, v34
  v_mul_f32 v155, v155, v34
  v_mul_f32 v160, v160, v34
  v_mul_f32 v161, v161, v34
  v_mul_f32 v162, v162, v34
  v_mul_f32 v163, v163, v34
  v_mul_f32 v168, v168, v34
  v_mul_f32 v169, v169, v34
  v_mul_f32 v170, v170, v34
  v_mul_f32 v171, v171, v34
  v_mul_f32 v176, v176, v34
  v_mul_f32 v177, v177, v34
  v_mul_f32 v178, v178, v34
  v_mul_f32 v179, v179, v34
  v_mul_f32 v184, v184, v34
  v_mul_f32 v185, v185, v34
  v_mul_f32 v186, v186, v34
  v_mul_f32 v187, v187, v34
  v_mul_f32 v192, v192, v34
  v_mul_f32 v193, v193, v34
  v_mul_f32 v194, v194, v34
  v_mul_f32 v195, v195, v34
  v_mul_f32 v200, v200, v34
  v_mul_f32 v201, v201, v34
  v_mul_f32 v202, v202, v34
  v_mul_f32 v203, v203, v34
  v_mul_f32 v208, v208, v34
  v_mul_f32 v209, v209, v34
  v_mul_f32 v210, v210, v34
  v_mul_f32 v211, v211, v34
  v_max3_f32 v33, v104, v105, v106
  v_max3_f32 v33, v33, v107, v108
  v_max3_f32 v33, v33, v109, v110
  v_max3_f32 v33, v33, v111, v112
  v_max3_f32 v33, v33, v113, v114
  v_max3_f32 v33, v33, v115, v116
  v_max3_f32 v33, v33, v117, v118
  v_max_f32 v33, v33, v119
  v_mov_b32 v30, v33
  s_nop 1
  v_permlane32_swap_b32 v33, v30
  s_nop 1
  v_max_f32 v33, v33, v30
  v_mov_b32 v30, v33
  s_nop 1
  v_permlane16_swap_b32 v33, v30
  s_nop 1
  v_max_f32 v33, v33, v30
  v_max_f32 v33, 0, v33
  v_sub_f32 v30, 0, v33
  v_exp_f32 v35, v30
  v_sub_f32 v104, v104, v33
  v_sub_f32 v105, v105, v33
  v_sub_f32 v106, v106, v33
  v_sub_f32 v107, v107, v33
  v_sub_f32 v108, v108, v33
  v_sub_f32 v109, v109, v33
  v_sub_f32 v110, v110, v33
  v_sub_f32 v111, v111, v33
  v_sub_f32 v112, v112, v33
  v_sub_f32 v113, v113, v33
  v_sub_f32 v114, v114, v33
  v_sub_f32 v115, v115, v33
  v_sub_f32 v116, v116, v33
  v_sub_f32 v117, v117, v33
  v_sub_f32 v118, v118, v33
  v_sub_f32 v119, v119, v33
  v_sub_f32 v76, v76, v33
  v_sub_f32 v77, v77, v33
  v_sub_f32 v78, v78, v33
  v_sub_f32 v79, v79, v33
  v_mul_f32 v84, v84, v35
  v_mul_f32 v85, v85, v35
  v_mul_f32 v86, v86, v35
  v_mul_f32 v87, v87, v35
  v_mul_f32 v156, v156, v35
  v_mul_f32 v157, v157, v35
  v_mul_f32 v158, v158, v35
  v_mul_f32 v159, v159, v35
  v_mul_f32 v164, v164, v35
  v_mul_f32 v165, v165, v35
  v_mul_f32 v166, v166, v35
  v_mul_f32 v167, v167, v35
  v_mul_f32 v172, v172, v35
  v_mul_f32 v173, v173, v35
  v_mul_f32 v174, v174, v35
  v_mul_f32 v175, v175, v35
  v_mul_f32 v180, v180, v35
  v_mul_f32 v181, v181, v35
  v_mul_f32 v182, v182, v35
  v_mul_f32 v183, v183, v35
  v_mul_f32 v188, v188, v35
  v_mul_f32 v189, v189, v35
  v_mul_f32 v190, v190, v35
  v_mul_f32 v191, v191, v35
  v_mul_f32 v196, v196, v35
  v_mul_f32 v197, v197, v35
  v_mul_f32 v198, v198, v35
  v_mul_f32 v199, v199, v35
  v_mul_f32 v204, v204, v35
  v_mul_f32 v205, v205, v35
  v_mul_f32 v206, v206, v35
  v_mul_f32 v207, v207, v35
  v_mul_f32 v212, v212, v35
  v_mul_f32 v213, v213, v35
  v_mul_f32 v214, v214, v35
  v_mul_f32 v215, v215, v35
  s_nop 3
  s_branch L_rare1_ret
L_rare2:
  s_nop 15
  v_max3_f32 v32, v120, v121, v122
  v_max3_f32 v32, v32, v123, v124
  v_max3_f32 v32, v32, v125, v126
  v_max3_f32 v32, v32, v127, v128
  v_max3_f32 v32, v32, v129, v130
  v_max3_f32 v32, v32, v131, v132
  v_max3_f32 v32, v32, v133, v134
  v_max_f32 v32, v32, v135
  v_mov_b32 v30, v32
  s_nop 1
  v_permlane32_swap_b32 v32, v30
  s_nop 1
  v_max_f32 v32, v32, v30
  v_mov_b32 v30, v32
  s_nop 1
  v_permlane16_swap_b32 v32, v30
  s_nop 1
  v_max_f32 v32, v32, v30
  v_max_f32 v32, 0, v32
  v_sub_f32 v30, 0, v32
  v_exp_f32 v34, v30
  v_sub_f32 v120, v120, v32
  v_sub_f32 v121, v121, v32
  v_sub_f32 v122, v122, v32
  v_sub_f32 v123, v123, v32
  v_sub_f32 v124, v124, v32
  v_sub_f32 v125, v125, v32
  v_sub_f32 v126, v126, v32
  v_sub_f32 v127, v127, v32
  v_sub_f32 v128, v128, v32
  v_sub_f32 v129, v129, v32
  v_sub_f32 v130, v130, v32
  v_sub_f32 v131, v131, v32
  v_sub_f32 v132, v132, v32
  v_sub_f32 v133, v133, v32
  v_sub_f32 v134, v134, v32
  v_sub_f32 v135, v135, v32
  v_sub_f32 v72, v72, v32
  v_sub_f32 v73, v73, v32
  v_sub_f32 v74, v74, v32
  v_sub_f32 v75, v75, v32
  v_mul_f32 v80, v80, v34
  v_mul_f32 v81, v81, v34
  v_mul_f32 v82, v82, v34
  v_mul_f32 v83, v83, v34
  v_mul_f32 v152, v152, v34
  v_mul_f32 v153, v153, v34
  v_mul_f32 v154, v154, v34
  v_mul_f32 v155, v155, v34
  v_mul_f32 v160, v160, v34
  v_mul_f32 v161, v161, v34
  v_mul_f32 v162, v162, v34
  v_mul_f32 v163, v163, v34
  v_mul_f32 v168, v168, v34
  v_mul_f32 v169, v169, v34
  v_mul_f32 v170, v170, v34
  v_mul_f32 v171, v171, v34
  v_mul_f32 v176, v176, v34
  v_mul_f32 v177, v177, v34
  v_mul_f32 v178, v178, v34
  v_mul_f32 v179, v179, v34
  v_mul_f32 v184, v184, v34
  v_mul_f32 v185, v185, v34
  v_mul_f32 v186, v186, v34
  v_mul_f32 v187, v187, v34
  v_mul_f32 v192, v192, v34
  v_mul_f32 v193, v193, v34
  v_mul_f32 v194, v194, v34
  v_mul_f32 v195, v195, v34
  v_mul_f32 v200, v200, v34
  v_mul_f32 v201, v201, v34
  v_mul_f32 v202, v202, v34
  v_mul_f32 v203, v203, v34
  v_mul_f32 v208, v208, v34
  v_mul_f32 v209, v209, v34
  v_mul_f32 v210, v210, v34
  v_mul_f32 v211, v211, v34
  v_max3_f32 v33, v136, v137, v138
  v_max3_f32 v33, v33, v139, v140
  v_max3_f32 v33, v33, v141, v142
  v_max3_f32 v33, v33, v143, v144
  v_max3_f32 v33, v33, v145, v146
  v_max3_f32 v33, v33, v147, v148
  v_max3_f32 v33, v33, v149, v150
  v_max_f32 v33, v33, v151
  v_mov_b32 v30, v33
  s_nop 1
  v_permlane32_swap_b32 v33, v30
  s_nop 1
  v_max_f32 v33, v33, v30
  v_mov_b32 v30, v33
  s_nop 1
  v_permlane16_swap_b32 v33, v30
  s_nop 1
  v_max_f32 v33, v33, v30
  v_max_f32 v33, 0, v33
  v_sub_f32 v30, 0, v33
  v_exp_f32 v35, v30
  v_sub_f32 v136, v136, v33
  v_sub_f32 v137, v137, v33
  v_sub_f32 v138, v138, v33
  v_sub_f32 v139, v139, v33
  v_sub_f32 v140, v140, v33
  v_sub_f32 v141, v141, v33
  v_sub_f32 v142, v142, v33
  v_sub_f32 v143, v143, v33
  v_sub_f32 v144, v144, v33
  v_sub_f32 v145, v145, v33
  v_sub_f32 v146, v146, v33
  v_sub_f32 v147, v147, v33
  v_sub_f32 v148, v148, v33
  v_sub_f32 v149, v149, v33
  v_sub_f32 v150, v150, v33
  v_sub_f32 v151, v151, v33
  v_sub_f32 v76, v76, v33
  v_sub_f32 v77, v77, v33
  v_sub_f32 v78, v78, v33
  v_sub_f32 v79, v79, v33
  v_mul_f32 v84, v84, v35
  v_mul_f32 v85, v85, v35
  v_mul_f32 v86, v86, v35
  v_mul_f32 v87, v87, v35
  v_mul_f32 v156, v156, v35
  v_mul_f32 v157, v157, v35
  v_mul_f32 v158, v158, v35
  v_mul_f32 v159, v159, v35
  v_mul_f32 v164, v164, v35
  v_mul_f32 v165, v165, v35
  v_mul_f32 v166, v166, v35
  v_mul_f32 v167, v167, v35
  v_mul_f32 v172, v172, v35
  v_mul_f32 v173, v173, v35
  v_mul_f32 v174, v174, v35
  v_mul_f32 v175, v175, v35
  v_mul_f32 v180, v180, v35
  v_mul_f32 v181, v181, v35
  v_mul_f32 v182, v182, v35
  v_mul_f32 v183, v183, v35
  v_mul_f32 v188, v188, v35
  v_mul_f32 v189, v189, v35
  v_mul_f32 v190, v190, v35
  v_mul_f32 v191, v191, v35
  v_mul_f32 v196, v196, v35
  v_mul_f32 v197, v197, v35
  v_mul_f32 v198, v198, v35
  v_mul_f32 v199, v199, v35
  v_mul_f32 v204, v204, v35
  v_mul_f32 v205, v205, v35
  v_mul_f32 v206, v206, v35
  v_mul_f32 v207, v207, v35
  v_mul_f32 v212, v212, v35
  v_mul_f32 v213, v213, v35
  v_mul_f32 v214, v214, v35
  v_mul_f32 v215, v215, v35
  s_nop 3
  s_branch L_rare2_ret
L_rare3:
  s_nop 15
  v_max3_f32 v32, v88, v89, v90
  v_max3_f32 v32, v32, v91, v92
  v_max3_f32 v32, v32, v93, v94
  v_max3_f32 v32, v32, v95, v96
  v_max3_f32 v32, v32, v97, v98
  v_max3_f32 v32, v32, v99, v100
  v_max3_f32 v32, v32, v101, v102
  v_max_f32 v32, v32, v103
  v_mov_b32 v30, v32
  s_nop 1
  v_permlane32_swap_b32 v32, v30
  s_nop 1
  v_max_f32 v32, v32, v30
  v_mov_b32 v30, v32
  s_nop 1
  v_permlane16_swap_b32 v32, v30
  s_nop 1
  v_max_f32 v32, v32, v30
  v_max_f32 v32, 0, v32
  v_sub_f32 v30, 0, v32
  v_exp_f32 v34, v30
  v_sub_f32 v88, v88, v32
  v_sub_f32 v89, v89, v32
  v_sub_f32 v90, v90, v32
  v_sub_f32 v91, v91, v32
  v_sub_f32 v92, v92, v32
  v_sub_f32 v93, v93, v32
  v_sub_f32 v94, v94, v32
  v_sub_f32 v95, v95, v32
  v_sub_f32 v96, v96, v32
  v_sub_f32 v97, v97, v32
  v_sub_f32 v98, v98, v32
  v_sub_f32 v99, v99, v32
  v_sub_f32 v100, v100, v32
  v_sub_f32 v101, v101, v32
  v_sub_f32 v102, v102, v32
  v_sub_f32 v103, v103, v32
  v_sub_f32 v72, v72, v32
  v_sub_f32 v73, v73, v32
  v_sub_f32 v74, v74, v32
  v_sub_f32 v75, v75, v32
  v_mul_f32 v80, v80, v34
  v_mul_f32 v81, v81, v34
  v_mul_f32 v82, v82, v34
  v_mul_f32 v83, v83, v34
  v_mul_f32 v152, v152, v34
  v_mul_f32 v153, v153, v34
  v_mul_f32 v154, v154, v34
  v_mul_f32 v155, v155, v34
  v_mul_f32 v160, v160, v34
  v_mul_f32 v161, v161, v34
  v_mul_f32 v162, v162, v34
  v_mul_f32 v163, v163, v34
  v_mul_f32 v168, v168, v34
  v_mul_f32 v169, v169, v34
  v_mul_f32 v170, v170, v34
  v_mul_f32 v171, v171, v34
  v_mul_f32 v176, v176, v34
  v_mul_f32 v177, v177, v34
  v_mul_f32 v178, v178, v34
  v_mul_f32 v179, v179, v34
  v_mul_f32 v184, v184, v34
  v_mul_f32 v185, v185, v34
  v_mul_f32 v186, v186, v34
  v_mul_f32 v187, v187, v34
  v_mul_f32 v192, v192, v34
  v_mul_f32 v193, v193, v34
  v_mul_f32 v194, v194, v34
  v_mul_f32 v195, v195, v34
  v_mul_f32 v200, v200, v34
  v_mul_f32 v201, v201, v34
  v_mul_f32 v202, v202, v34
  v_mul_f32 v203, v203, v34
  v_mul_f32 v208, v208, v34
  v_mul_f32 v209, v209, v34
  v_mul_f32 v210, v210, v34
  v_mul_f32 v211, v211, v34
  v_max3_f32 v33, v104, v105, v106
  v_max3_f32 v33, v33, v107, v108
  v_max3_f32 v33, v33, v109, v110
  v_max3_f32 v33, v33, v111, v112
  v_max3_f32 v33, v33, v113, v114
  v_max3_f32 v33, v33, v115, v116
  v_max3_f32 v33, v33, v117, v118
  v_max_f32 v33, v33, v119
  v_mov_b32 v30, v33
  s_nop 1
  v_permlane32_swap_b32 v33, v30
  s_nop 1
  v_max_f32 v33, v33, v30
  v_mov_b32 v30, v33
  s_nop 1
  v_permlane16_swap_b32 v33, v30
  s_nop 1
  v_max_f32 v33, v33, v30
  v_max_f32 v33, 0, v33
  v_sub_f32 v30, 0, v33
  v_exp_f32 v35, v30
  v_sub_f32 v104, v104, v33
  v_sub_f32 v105, v105, v33
  v_sub_f32 v106, v106, v33
  v_sub_f32 v107, v107, v33
  v_sub_f32 v108, v108, v33
  v_sub_f32 v109, v109, v33
  v_sub_f32 v110, v110, v33
  v_sub_f32 v111, v111, v33
  v_sub_f32 v112, v112, v33
  v_sub_f32 v113, v113, v33
  v_sub_f32 v114, v114, v33
  v_sub_f32 v115, v115, v33
  v_sub_f32 v116, v116, v33
  v_sub_f32 v117, v117, v33
  v_sub_f32 v118, v118, v33
  v_sub_f32 v119, v119, v33
  v_sub_f32 v76, v76, v33
  v_sub_f32 v77, v77, v33
  v_sub_f32 v78, v78, v33
  v_sub_f32 v79, v79, v33
  v_mul_f32 v84, v84, v35
  v_mul_f32 v85, v85, v35
  v_mul_f32 v86, v86, v35
  v_mul_f32 v87, v87, v35
  v_mul_f32 v156, v156, v35
  v_mul_f32 v157, v157, v35
  v_mul_f32 v158, v158, v35
  v_mul_f32 v159, v159, v35
  v_mul_f32 v164, v164, v35
  v_mul_f32 v165, v165, v35
  v_mul_f32 v166, v166, v35
  v_mul_f32 v167, v167, v35
  v_mul_f32 v172, v172, v35
  v_mul_f32 v173, v173, v35
  v_mul_f32 v174, v174, v35
  v_mul_f32 v175, v175, v35
  v_mul_f32 v180, v180, v35
  v_mul_f32 v181, v181, v35
  v_mul_f32 v182, v182, v35
  v_mul_f32 v183, v183, v35
  v_mul_f32 v188, v188, v35
  v_mul_f32 v189, v189, v35
  v_mul_f32 v190, v190, v35
  v_mul_f32 v191, v191, v35
  v_mul_f32 v196, v196, v35
  v_mul_f32 v197, v197, v35
  v_mul_f32 v198, v198, v35
  v_mul_f32 v199, v199, v35
  v_mul_f32 v204, v204, v35
  v_mul_f32 v205, v205, v35
  v_mul_f32 v206, v206, v35
  v_mul_f32 v207, v207, v35
  v_mul_f32 v212, v212, v35
  v_mul_f32 v213, v213, v35
  v_mul_f32 v214, v214, v35
  v_mul_f32 v215, v215, v35
  s_nop 3
  s_branch L_rare3_ret
L_rare2p:
  s_nop 15
  v_max3_f32 v32, v120, v121, v122
  v_max3_f32 v32, v32, v123, v124
  v_max3_f32 v32, v32, v125, v126
  v_max3_f32 v32, v32, v127, v128
  v_max3_f32 v32, v32, v129, v130
  v_max3_f32 v32, v32, v131, v132
  v_max3_f32 v32, v32, v133, v134
  v_max_f32 v32, v32, v135
  v_mov_b32 v30, v32
  s_nop 1
  v_permlane32_swap_b32 v32, v30
  s_nop 1
  v_max_f32 v32, v32, v30
  v_mov_b32 v30, v32
  s_nop 1
  v_permlane16_swap_b32 v32, v30
  s_nop 1
  v_max_f32 v32, v32, v30
  v_max_f32 v32, 0, v32
  v_sub_f32 v30, 0, v32
  v_exp_f32 v34, v30
  v_sub_f32 v120, v120, v32
  v_sub_f32 v121, v121, v32
  v_sub_f32 v122, v122, v32
  v_sub_f32 v123, v123, v32
  v_sub_f32 v124, v124, v32
  v_sub_f32 v125, v125, v32
  v_sub_f32 v126, v126, v32
  v_sub_f32 v127, v127, v32
  v_sub_f32 v128, v128, v32
  v_sub_f32 v129, v129, v32
  v_sub_f32 v130, v130, v32
  v_sub_f32 v131, v131, v32
  v_sub_f32 v132, v132, v32
  v_sub_f32 v133, v133, v32
  v_sub_f32 v134, v134, v32
  v_sub_f32 v135, v135, v32
  v_sub_f32 v72, v72, v32
  v_sub_f32 v73, v73, v32
  v_sub_f32 v74, v74, v32
  v_sub_f32 v75, v75, v32
  v_mul_f32 v80, v80, v34
  v_mul_f32 v81, v81, v34
  v_mul_f32 v82, v82, v34
  v_mul_f32 v83, v83, v34
  v_mul_f32 v152, v152, v34
  v_mul_f32 v153, v153, v34
  v_mul_f32 v154, v154, v34
  v_mul_f32 v155, v155, v34
  v_mul_f32 v160, v160, v34
  v_mul_f32 v161, v161, v34
  v_mul_f32 v162, v162, v34
  v_mul_f32 v163, v163, v34
  v_mul_f32 v168, v168, v34
  v_mul_f32 v169, v169, v34
  v_mul_f32 v170, v170, v34
  v_mul_f32 v171, v171, v34
  v_mul_f32 v176, v176, v34
  v_mul_f32 v177, v177, v34
  v_mul_f32 v178, v178, v34
  v_mul_f32 v179, v179, v34
  v_mul_f32 v184, v184, v34
  v_mul_f32 v185, v185, v34
  v_mul_f32 v186, v186, v34
  v_mul_f32 v187, v187, v34
  v_mul_f32 v192, v192, v34
  v_mul_f32 v193, v193, v34
  v_mul_f32 v194, v194, v34
  v_mul_f32 v195, v195, v34
  v_mul_f32 v200, v200, v34
  v_mul_f32 v201, v201, v34
  v_mul_f32 v202, v202, v34
  v_mul_f32 v203, v203, v34
  v_mul_f32 v208, v208, v34
  v_mul_f32 v209, v209, v34
  v_mul_f32 v210, v210, v34
  v_mul_f32 v211, v211, v34
  v_max3_f32 v33, v136, v137, v138
  v_max3_f32 v33, v33, v139, v140
  v_max3_f32 v33, v33, v141, v142
  v_max3_f32 v33, v33, v143, v144
  v_max3_f32 v33, v33, v145, v146
  v_max3_f32 v33, v33, v147, v148
  v_max3_f32 v33, v33, v149, v150
  v_max_f32 v33, v33, v151
  v_mov_b32 v30, v33
  s_nop 1
  v_permlane32_swap_b32 v33, v30
  s_nop 1
  v_max_f32 v33, v33, v30
  v_mov_b32 v30, v33
  s_nop 1
  v_permlane16_swap_b32 v33, v30
  s_nop 1
  v_max_f32 v33, v33, v30
  v_max_f32 v33, 0, v33
  v_sub_f32 v30, 0, v33
  v_exp_f32 v35, v30
  v_sub_f32 v136, v136, v33
  v_sub_f32 v137, v137, v33
  v_sub_f32 v138, v138, v33
  v_sub_f32 v139, v139, v33
  v_sub_f32 v140, v140, v33
  v_sub_f32 v141, v141, v33
  v_sub_f32 v142, v142, v33
  v_sub_f32 v143, v143, v33
  v_sub_f32 v144, v144, v33
  v_sub_f32 v145, v145, v33
  v_sub_f32 v146, v146, v33
  v_sub_f32 v147, v147, v33
  v_sub_f32 v148, v148, v33
  v_sub_f32 v149, v149, v33
  v_sub_f32 v150, v150, v33
  v_sub_f32 v151, v151, v33
  v_sub_f32 v76, v76, v33
  v_sub_f32 v77, v77, v33
  v_sub_f32 v78, v78, v33
  v_sub_f32 v79, v79, v33
  v_mul_f32 v84, v84, v35
  v_mul_f32 v85, v85, v35
  v_mul_f32 v86, v86, v35
  v_mul_f32 v87, v87, v35
  v_mul_f32 v156, v156, v35
  v_mul_f32 v157, v157, v35
  v_mul_f32 v158, v158, v35
  v_mul_f32 v159, v159, v35
  v_mul_f32 v164, v164, v35
  v_mul_f32 v165, v165, v35
  v_mul_f32 v166, v166, v35
  v_mul_f32 v167, v167, v35
  v_mul_f32 v172, v172, v35
  v_mul_f32 v173, v173, v35
  v_mul_f32 v174, v174, v35
  v_mul_f32 v175, v175, v35
  v_mul_f32 v180, v180, v35
  v_mul_f32 v181, v181, v35
  v_mul_f32 v182, v182, v35
  v_mul_f32 v183, v183, v35
  v_mul_f32 v188, v188, v35
  v_mul_f32 v189, v189, v35
  v_mul_f32 v190, v190, v35
  v_mul_f32 v191, v191, v35
  v_mul_f32 v196, v196, v35
  v_mul_f32 v197, v197, v35
  v_mul_f32 v198, v198, v35
  v_mul_f32 v199, v199, v35
  v_mul_f32 v204, v204, v35
  v_mul_f32 v205, v205, v35
  v_mul_f32 v206, v206, v35
  v_mul_f32 v207, v207, v35
  v_mul_f32 v212, v212, v35
  v_mul_f32 v213, v213, v35
  v_mul_f32 v214, v214, v35
  v_mul_f32 v215, v215, v35
  s_nop 3
  s_branch L_rare2p_ret

.section .rodata,"a"
.p2align 6
.amdhsa_kernel standalone__mha_block_cached__near_ridge_kernel
  .amdhsa_next_free_vgpr 512
  .amdhsa_next_free_sgpr 102
  .amdhsa_accum_offset 256
  .amdhsa_group_segment_fixed_size 0
  .amdhsa_kernarg_size 64
  .amdhsa_user_sgpr_count 2
  .amdhsa_user_sgpr_kernarg_segment_ptr 1
  .amdhsa_system_sgpr_workgroup_id_x 1
.end_amdhsa_kernel
```
